```python
import torch

def _softmax(x, axis=-1):
    return torch.softmax(x, dim=axis)
def _gelu(x):
    return torch.nn.functional.gelu(x, approximate="tanh")
def _silu(x):
    return torch.nn.functional.silu(x)
def _sigmoid(x):
    return torch.sigmoid(x)
def _layernorm(x, axis=-1, eps=1e-5):
    m = x.mean(dim=axis, keepdim=True)
    v = x.var(dim=axis, keepdim=True, unbiased=False)
    return (x - m) / torch.sqrt(v + eps)
def _scatter_add(tgt, idx, src, axis=0):
    return tgt.clone().index_add_(axis, idx, src)
def _segment_sum(src, seg, n):
    out = torch.zeros((n,) + src.shape[1:], dtype=src.dtype)
    return out.index_add_(0, seg, src)
def _pad(x, pw):
    flat = tuple(v for pair in reversed(pw) for v in pair)
    return torch.nn.functional.pad(x, flat)

kernel_name = 'gated_mix__linear_kernel_hedgehog__mha_block__prompt'

def setup_inputs():

    _w = (lambda a: (lambda t: t.to(torch.bfloat16) if t.is_floating_point() else t)(torch.as_tensor(a)))
    def _A_setup():
        B, S, D, H = 1, 2048, 1024, 32
        Dh = D // H
        return {
            "x": _w((lambda *s: torch.randn(*s, dtype=torch.bfloat16) * 0.05)(B, S, D)),
            "wqkv": _w((lambda *s: torch.randn(*s, dtype=torch.bfloat16) * 3.2)(D, 3 * D)),
            "w_phi": _w((lambda *s: torch.randn(*s, dtype=torch.bfloat16) * 3.2)(H, Dh, Dh) * (Dh ** -0.5)),
            "wo": _w((lambda *s: torch.randn(*s, dtype=torch.bfloat16) * 1.6)(D, D)),
        }
    _A_in = _A_setup()

    def _B_setup():
        B, S, D, H = 1, 2048, 1024, 32
        return {
            "x": _w((lambda *s: torch.randn(*s, dtype=torch.bfloat16) * 0.05)(B, S, D)),
            "wqkv": _w((lambda *s: torch.randn(*s, dtype=torch.bfloat16) * 3.2)(D, 3 * D)),
            "wo": _w((lambda *s: torch.randn(*s, dtype=torch.bfloat16) * 0.1)(D, D)),
        }
    _B_in = _B_setup()

    return {
        "A_x": _A_in["x"],
        "A_wqkv": _A_in["wqkv"],
        "A_w_phi": _A_in["w_phi"],
        "A_wo": _A_in["wo"],
        "B_x": _B_in["x"],
        "B_wqkv": _B_in["wqkv"],
        "B_wo": _B_in["wo"],
        "gate_w": _w((lambda *s: torch.randn(*s, dtype=torch.bfloat16) * 0.4)(1024) * 16.0),
    }

def reference(A_x, A_wqkv, A_w_phi, A_wo, B_x, B_wqkv, B_wo, gate_w):
    def _A_ref(x, wqkv, w_phi, wo):
        B, S, D = x.shape
        H = 32; Dh = D // H
        qkv = (lambda x, *d: x.permute(*d))((x @ wqkv).reshape(B, S, 3, H, Dh), 2, 0, 3, 1, 4)
        q, k, v = qkv[0], qkv[1], qkv[2]
        pq = torch.einsum("bhsd,hdf->bhsf", q, w_phi)
        pk = torch.einsum("bhsd,hdf->bhsf", k, w_phi)
        phi_q = torch.concatenate([_softmax(pq, axis=-1), _softmax(-pq, axis=-1)], axis=-1)
        phi_k = torch.concatenate([_softmax(pk, axis=-1), _softmax(-pk, axis=-1)], axis=-1)
        kv = torch.einsum("bhsf,bhsd->bhfd", phi_k, v)
        z  = torch.einsum("bhsf->bhf", phi_k)
        num = torch.einsum("bhqf,bhfd->bhqd", phi_q, kv)
        den = torch.einsum("bhqf,bhf->bhq", phi_q, z)[..., None] + 1e-6
        o = num / den
        return (lambda x, *d: x.permute(*d))(o, 0, 2, 1, 3).reshape(B, S, D) @ wo

    def _B_ref(x, wqkv, wo):
        B, S, D = x.shape
        H = 32
        Dh = D // H
        qkv = (lambda x, *d: x.permute(*d))((x @ wqkv).reshape(B, S, 3, H, Dh), 2, 0, 3, 1, 4)
        q, k, v = qkv[0], qkv[1], qkv[2]
        scores = torch.einsum("bhqd,bhkd->bhqk", q, k) * (Dh ** -0.5)
        p = _softmax(scores, axis=-1)
        o = torch.einsum("bhqk,bhkd->bhqd", p, v)
        return (lambda x, *d: x.permute(*d))(o, 0, 2, 1, 3).reshape(B, S, D) @ wo

    x = A_x
    g = _sigmoid((x * gate_w).sum(-1, keepdims=True))
    a = _A_ref(x, A_wqkv, A_w_phi, A_wo)
    b = _B_ref(x, B_wqkv, B_wo)
    return g * a + (1 - g) * b
```

```asm
; @launch grid=(256,1,1) block=(512,1,1) lds=163840
.amdgcn_target "amdgcn-amd-amdhsa--gfx950"
.text
.globl gated_mix__linear_kernel_hedgehog__mha_block__prompt_kernel
.p2align 8
.type gated_mix__linear_kernel_hedgehog__mha_block__prompt_kernel,@function
gated_mix__linear_kernel_hedgehog__mha_block__prompt_kernel:
    s_cmp_ge_u32 s2, 256
    s_cbranch_scc1 L_end
    s_load_dwordx4 s[28:31], s[0:1], 0
    s_load_dwordx4 s[32:35], s[0:1], 16
    s_load_dwordx4 s[36:39], s[0:1], 40
    s_load_dwordx4 s[40:43], s[0:1], 56
    s_load_dwordx4 s[44:47], s[0:1], 72
    v_and_b32 v253, 63, v0
    v_lshrrev_b32 v155, 6, v0
    v_lshlrev_b32 v254, 4, v253
    v_readfirstlane_b32 s48, v155
    v_lshrrev_b32 v255, 5, v253
    s_and_b32 s64, s2, 7
    s_lshr_b32 s65, s2, 3
    s_and_b32 s66, s65, 1
    s_lshl_b32 s52, s64, 1
    s_add_u32 s52, s52, s66
    s_xor_b32 s52, s52, 6
    s_lshr_b32 s53, s65, 1
    s_lshr_b32 s49, s48, 2
    s_lshr_b32 s54, s48, 1
    s_and_b32 s50, s54, 1
    s_and_b32 s51, s48, 1
    s_lshl_b32 s55, s52, 1
    s_add_u32 s55, s55, s50
    s_lshl_b32 s64, s53, 7
    s_lshl_b32 s65, s48, 3
    s_add_u32 s64, s64, s65
    v_lshrrev_b32 v155, 3, v253
    v_add_u32 v155, s64, v155
    v_lshlrev_b32 v155, 11, v155
    s_lshl_b32 s65, s51, 2
    v_lshrrev_b32 v156, 4, v253
    v_add_u32 v156, s65, v156
    v_xor_b32 v156, v156, v253
    v_and_b32 v156, 7, v156
    v_lshl_add_u32 v150, v156, 4, v155
    s_lshl_b32 s57, s48, 10
    s_add_u32 s57, s57, 0x0
    s_and_b32 s64, s48, 3
    s_lshl_b32 s65, s64, 3
    v_bfe_u32 v155, v253, 2, 3
    v_add_u32 v155, s65, v155
    v_mul_u32_u24 v155, 6144, v155
    v_lshl_add_u32 v155, v255, 6, v155
    v_and_b32 v156, 3, v253
    v_lshl_add_u32 v155, v156, 4, v155
    s_lshl_b32 s65, s52, 7
    v_add_u32 v149, s65, v155
    s_lshl_b32 s64, s64, 10
    s_mul_i32 s65, s49, 12288
    s_add_u32 s56, s64, s65
    s_add_u32 s56, s56, 0xc000
    v_mov_b32 v156, 0
    v_mov_b32 v157, 0
    v_mov_b32 v158, 0
    v_mov_b32 v159, 0
    s_waitcnt lgkmcnt(0)
    s_mov_b32 s4, s28
    s_mov_b32 s5, s29
    s_mov_b32 s6, 0x400000
    s_mov_b32 s7, 0x20000
    s_cmp_eq_u32 s49, 1
    s_cselect_b32 s8, s36, s30
    s_cselect_b32 s9, s37, s31
    s_mov_b32 s10, 0x600000
    s_mov_b32 s11, 0x20000
    s_mov_b32 s12, s46
    s_mov_b32 s13, s47
    s_mov_b32 s14, 0x1400000
    s_mov_b32 s15, 0x20000
    s_or_b32 s64, s2, s48
    s_cmp_lg_u32 s64, 0
    s_cbranch_scc1 L_noclear_1
    s_mov_b32 s65, 0x1300000
    buffer_store_dwordx4 v[156:159], v254, s[12:15], s65 offen sc1
    s_mov_b32 s65, 0x1300400
    buffer_store_dwordx4 v[156:159], v254, s[12:15], s65 offen sc1
    s_mov_b32 s65, 0x1308000
    buffer_store_dwordx4 v[156:159], v254, s[12:15], s65 offen sc1
    s_mov_b32 s65, 0x1308400
    buffer_store_dwordx4 v[156:159], v254, s[12:15], s65 offen sc1
    s_mov_b32 s65, 0x1310000
    buffer_store_dwordx4 v[156:159], v254, s[12:15], s65 offen sc1
    s_mov_b32 s65, 0x1310400
    buffer_store_dwordx4 v[156:159], v254, s[12:15], s65 offen sc1
    s_mov_b32 s65, 0x1318000
    buffer_store_dwordx4 v[156:159], v254, s[12:15], s65 offen sc1
    s_mov_b32 s65, 0x1318400
    buffer_store_dwordx4 v[156:159], v254, s[12:15], s65 offen sc1
L_noclear_1:
    s_add_u32 m0, s57, 0x0
    s_mov_b32 s64, 0x0
    buffer_load_dwordx4 v150, s[4:7], s64 offen lds
    s_add_u32 m0, s56, 0x0
    s_mov_b32 s64, 0x0
    buffer_load_dwordx4 v149, s[8:11], s64 offen lds
    s_add_u32 m0, s56, 0x1000
    s_mov_b32 s64, 0x800
    buffer_load_dwordx4 v149, s[8:11], s64 offen lds
    s_add_u32 m0, s56, 0x2000
    s_mov_b32 s64, 0x1000
    buffer_load_dwordx4 v149, s[8:11], s64 offen lds
    s_add_u32 m0, s57, 0x2000
    s_mov_b32 s64, 0x20000
    buffer_load_dwordx4 v150, s[4:7], s64 offen lds
    s_cmp_eq_u32 s49, 1
    s_cselect_b32 s24, s40, s32
    s_cselect_b32 s25, s41, s33
    s_movk_i32 s26, 2048
    s_cselect_b32 s26, s26, 0x10000
    s_mov_b32 s27, 0x20000
    s_and_b32 s64, s48, 3
    s_lshl_b32 s64, s64, 10
    s_lshl_b32 s65, s52, 12
    s_add_u32 s65, s65, s64
    s_add_u32 s64, s64, 0x24000
    s_lshl_b32 s66, s51, 10
    s_add_u32 s67, s66, 0x25000
    s_cmp_eq_u32 s49, 1
    s_cselect_b32 s65, s66, s65
    s_cselect_b32 m0, s67, s64
    s_nop 0
    buffer_load_dwordx4 v254, s[24:27], s65 offen lds
    s_add_u32 m0, s56, 0x6000
    s_mov_b32 s64, 0x30000
    buffer_load_dwordx4 v149, s[8:11], s64 offen lds
    s_add_u32 m0, s56, 0x7000
    s_mov_b32 s64, 0x30800
    buffer_load_dwordx4 v149, s[8:11], s64 offen lds
    s_add_u32 m0, s56, 0x8000
    s_mov_b32 s64, 0x31000
    buffer_load_dwordx4 v149, s[8:11], s64 offen lds
    s_cmp_lt_u32 s2, 16
    s_cbranch_scc0 L_nocpf_2
    s_getpc_b64 s[24:25]
L_pcbase:
    s_mov_b32 s26, L_codeend-L_pcbase
    s_mov_b32 s27, 0x20000
    v_lshlrev_b32 v156, 7, v0
    buffer_load_dword v164, v156, s[24:27], 0 offen
L_nocpf_2:
    s_mov_b32 s27, 0x20000
    s_lshl_b32 s64, s48, 8
    s_add_u32 s64, s64, s2
    s_bitcmp1_b32 s64, 0
    s_cselect_b32 s24, s36, s30
    s_cselect_b32 s25, s37, s31
    s_mov_b32 s26, 0x600000
    s_lshr_b32 s65, s64, 1
    s_lshl_b32 s89, s65, 13
    s_mul_i32 s65, s65, 1366
    s_lshr_b32 s65, s65, 16
    s_sub_u32 s66, s64, 1536
    s_lshl_b32 s66, s66, 13
    s_cmp_ge_u32 s64, 1536
    s_cselect_b32 s24, s28, s24
    s_cselect_b32 s25, s29, s25
    s_cselect_b32 s26, 0x400000, s26
    s_cselect_b32 s89, s66, s89
    s_cselect_b32 s65, 200, s65
    s_cmp_lt_u32 s65, 2
    s_cselect_b32 s65, 200, s65
    s_sub_u32 s88, s65, 3
    v_lshlrev_b32 v166, 7, v253
    s_cmp_lt_i32 s88, 0
    s_cbranch_scc0 L_pfj_3
    buffer_load_dword v164, v166, s[24:27], s89 offen
L_pfj_3:
    v_lshlrev_b32 v156, 2, v0
    v_add_u32 v156, 0x27800, v156
    ds_write_b32 v156, v158
    s_mov_b32 s69, 0x3fb8aa3b
    s_mov_b32 s70, 0x3e8293ee
    s_mov_b32 s76, 4096
    v_bfe_u32 v155, v253, 2, 2
    v_lshlrev_b32 v155, 6, v155
    v_bfe_u32 v156, v253, 4, 1
    v_lshl_add_u32 v155, v156, 5, v155
    v_and_b32 v156, 3, v253
    v_lshl_add_u32 v155, v156, 3, v155
    v_lshl_add_u32 v142, v255, 10, v155
    s_mul_i32 s64, s49, 12288
    s_lshl_b32 s65, s50, 9
    s_add_u32 s64, s64, s65
    s_add_u32 s64, s64, 0xc000
    v_add_u32 v142, s64, v142
    v_and_b32 v155, 31, v253
    s_lshl_b32 s64, s51, 6
    v_add_u32 v155, s64, v155
    v_lshlrev_b32 v155, 7, v155
    v_bfe_u32 v156, v253, 1, 3
    v_xor_b32 v156, v156, v255
    v_xor_b32 v157, 0, v156
    v_lshl_add_u32 v144, v157, 4, v155
    v_xor_b32 v157, 2, v156
    v_lshl_add_u32 v145, v157, 4, v155
    v_xor_b32 v157, 4, v156
    v_lshl_add_u32 v146, v157, 4, v155
    v_xor_b32 v157, 6, v156
    v_lshl_add_u32 v147, v157, 4, v155
    s_lshl_b32 s64, s54, 5
    s_add_u32 s64, s64, 0x25000
    v_lshlrev_b32 v155, 4, v255
    v_add_u32 v151, s64, v155
    v_mov_b32 v140, 0
    v_mov_b32 v141, 0
    s_mov_b32 s16, s42
    s_mov_b32 s17, s43
    s_mov_b32 s18, 0x400000
    s_mov_b32 s19, 0x20000
    s_mov_b32 s20, s44
    s_mov_b32 s21, s45
    s_mov_b32 s22, 0x100
    s_mov_b32 s23, 0x20000
    s_mov_b32 s58, 0
    s_mov_b32 s59, 0
    s_mov_b32 s60, 16384
    s_mov_b32 s61, 32768
    s_mov_b32 s62, 0xf0000
    s_mov_b32 s63, 0
    v_mov_b32 v143, v142
    v_mov_b32 v148, v144
    s_waitcnt vmcnt(3)
    s_waitcnt lgkmcnt(0)
    s_barrier
    s_or_b32 s64, s2, s48
    s_cmp_lg_u32 s64, 0
    s_cbranch_scc1 L_nopub_4
    v_mov_b32 v155, 1
    buffer_store_dword v155, off, s[20:23], 0 sc1
L_nopub_4:
    ds_read_b128 v[96:99], v148
    ds_read_b64_tr_b16 v[104:105], v143 offset:0
    ds_read_b64_tr_b16 v[106:107], v143 offset:256
    ds_read_b128 v[100:103], v148 offset:4096
    ds_read_b64_tr_b16 v[108:109], v143 offset:4096
    ds_read_b64_tr_b16 v[110:111], v143 offset:4352
    ds_read_b64_tr_b16 v[112:113], v143 offset:8192
    ds_read_b64_tr_b16 v[114:115], v143 offset:8448
    ds_read_b128 v[136:139], v151
    s_waitcnt lgkmcnt(0)
    v_add_u32 v148, s59, v145
    v_mfma_f32_32x32x16_bf16 v[0:15], v[104:107], v[96:99], 0
    ds_read_b128 v[116:119], v148
    ds_read_b64_tr_b16 v[124:125], v143 offset:2048
    ds_read_b64_tr_b16 v[126:127], v143 offset:2304
    v_mfma_f32_32x32x16_bf16 v[16:31], v[104:107], v[100:103], 0
    ds_read_b128 v[120:123], v148 offset:4096
    ds_read_b64_tr_b16 v[128:129], v143 offset:6144
    ds_read_b64_tr_b16 v[130:131], v143 offset:6400
    v_mfma_f32_32x32x16_bf16 v[32:47], v[108:111], v[96:99], 0
    ds_read_b64_tr_b16 v[132:133], v143 offset:10240
    ds_read_b64_tr_b16 v[134:135], v143 offset:10496
    s_cmp_eq_u32 s54, 0
    s_cbranch_scc0 L_nogate_5
    v_dot2_f32_bf16 v140, v96, v136, v140
    v_dot2_f32_bf16 v141, v100, v136, v141
    v_dot2_f32_bf16 v140, v97, v137, v140
    v_dot2_f32_bf16 v141, v101, v137, v141
    v_dot2_f32_bf16 v140, v98, v138, v140
    v_dot2_f32_bf16 v141, v102, v138, v141
    v_dot2_f32_bf16 v140, v99, v139, v140
    v_dot2_f32_bf16 v141, v103, v139, v141
L_nogate_5:
    v_mfma_f32_32x32x16_bf16 v[48:63], v[108:111], v[100:103], 0
    s_add_u32 m0, s56, 0xc000
    s_mov_b32 s64, 0x60000
    buffer_load_dwordx4 v149, s[8:11], s64 offen lds
    s_add_u32 m0, s56, 0xd000
    s_mov_b32 s64, 0x60800
    buffer_load_dwordx4 v149, s[8:11], s64 offen lds
    s_add_u32 m0, s56, 0xe000
    s_mov_b32 s64, 0x61000
    buffer_load_dwordx4 v149, s[8:11], s64 offen lds
    v_mfma_f32_32x32x16_bf16 v[64:79], v[96:99], v[112:115], 0
    s_add_u32 m0, s57, 0x4000
    s_mov_b32 s64, 0x80
    buffer_load_dwordx4 v150, s[4:7], s64 offen lds
    s_add_u32 m0, s57, 0x6000
    s_mov_b32 s64, 0x20080
    buffer_load_dwordx4 v150, s[4:7], s64 offen lds
    v_mfma_f32_32x32x16_bf16 v[80:95], v[100:103], v[112:115], 0
    s_waitcnt vmcnt(5)
    s_waitcnt lgkmcnt(0)
    s_barrier
    s_add_u32 s65, s58, 24576
    s_cmp_eq_u32 s65, 98304
    s_cselect_b32 s65, 0, s65
    v_add_u32 v143, s65, v142
    v_add_u32 v148, s59, v146
    v_mfma_f32_32x32x16_bf16 v[0:15], v[124:127], v[116:119], v[0:15]
    ds_read_b128 v[96:99], v148
    ds_read_b64_tr_b16 v[104:105], v143 offset:0
    ds_read_b64_tr_b16 v[106:107], v143 offset:256
    v_mfma_f32_32x32x16_bf16 v[16:31], v[124:127], v[120:123], v[16:31]
    ds_read_b128 v[100:103], v148 offset:4096
    ds_read_b64_tr_b16 v[108:109], v143 offset:4096
    ds_read_b64_tr_b16 v[110:111], v143 offset:4352
    v_mfma_f32_32x32x16_bf16 v[32:47], v[128:131], v[116:119], v[32:47]
    ds_read_b64_tr_b16 v[112:113], v143 offset:8192
    ds_read_b64_tr_b16 v[114:115], v143 offset:8448
    s_cmp_eq_u32 s54, 1
    s_cbranch_scc0 L_nogate_7
    v_dot2_f32_bf16 v140, v116, v136, v140
    v_dot2_f32_bf16 v141, v120, v136, v141
    v_dot2_f32_bf16 v140, v117, v137, v140
    v_dot2_f32_bf16 v141, v121, v137, v141
    v_dot2_f32_bf16 v140, v118, v138, v140
    v_dot2_f32_bf16 v141, v122, v138, v141
    v_dot2_f32_bf16 v140, v119, v139, v140
    v_dot2_f32_bf16 v141, v123, v139, v141
L_nogate_7:
    v_mfma_f32_32x32x16_bf16 v[48:63], v[128:131], v[120:123], v[48:63]
    s_add_u32 m0, s56, 0x12000
    s_mov_b32 s64, 0x90000
    buffer_load_dwordx4 v149, s[8:11], s64 offen lds
    s_add_u32 m0, s56, 0x13000
    s_mov_b32 s64, 0x90800
    buffer_load_dwordx4 v149, s[8:11], s64 offen lds
    v_mfma_f32_32x32x16_bf16 v[64:79], v[116:119], v[132:135], v[64:79]
    s_add_u32 m0, s56, 0x14000
    s_mov_b32 s64, 0x91000
    buffer_load_dwordx4 v149, s[8:11], s64 offen lds
    s_add_u32 m0, s57, 0x8000
    s_mov_b32 s64, 0x100
    buffer_load_dwordx4 v150, s[4:7], s64 offen lds
    s_mov_b32 s58, s65
    s_cmp_eq_u32 s88, s63
    s_cbranch_scc0 L_pfj_6
    buffer_load_dword v164, v166, s[24:27], s89 offen
L_pfj_6:
    v_mfma_f32_32x32x16_bf16 v[80:95], v[120:123], v[132:135], v[80:95]
    s_waitcnt lgkmcnt(0)
    v_add_u32 v148, s59, v147
    v_mfma_f32_32x32x16_bf16 v[0:15], v[104:107], v[96:99], v[0:15]
    ds_read_b128 v[116:119], v148
    ds_read_b64_tr_b16 v[124:125], v143 offset:2048
    ds_read_b64_tr_b16 v[126:127], v143 offset:2304
    v_mfma_f32_32x32x16_bf16 v[16:31], v[104:107], v[100:103], v[16:31]
    ds_read_b128 v[120:123], v148 offset:4096
    ds_read_b64_tr_b16 v[128:129], v143 offset:6144
    ds_read_b64_tr_b16 v[130:131], v143 offset:6400
    v_mfma_f32_32x32x16_bf16 v[32:47], v[108:111], v[96:99], v[32:47]
    ds_read_b64_tr_b16 v[132:133], v143 offset:10240
    ds_read_b64_tr_b16 v[134:135], v143 offset:10496
    s_cmp_eq_u32 s54, 2
    s_cbranch_scc0 L_nogate_8
    v_dot2_f32_bf16 v140, v96, v136, v140
    v_dot2_f32_bf16 v141, v100, v136, v141
    v_dot2_f32_bf16 v140, v97, v137, v140
    v_dot2_f32_bf16 v141, v101, v137, v141
    v_dot2_f32_bf16 v140, v98, v138, v140
    v_dot2_f32_bf16 v141, v102, v138, v141
    v_dot2_f32_bf16 v140, v99, v139, v140
    v_dot2_f32_bf16 v141, v103, v139, v141
L_nogate_8:
    v_mfma_f32_32x32x16_bf16 v[48:63], v[108:111], v[100:103], v[48:63]
    s_add_u32 m0, s56, 0x0
    s_mov_b32 s64, 0xc0000
    buffer_load_dwordx4 v149, s[8:11], s64 offen lds
    s_add_u32 m0, s56, 0x1000
    s_mov_b32 s64, 0xc0800
    buffer_load_dwordx4 v149, s[8:11], s64 offen lds
    v_mfma_f32_32x32x16_bf16 v[64:79], v[96:99], v[112:115], v[64:79]
    s_add_u32 m0, s56, 0x2000
    s_mov_b32 s64, 0xc1000
    buffer_load_dwordx4 v149, s[8:11], s64 offen lds
    s_add_u32 m0, s57, 0xa000
    s_mov_b32 s64, 0x20100
    buffer_load_dwordx4 v150, s[4:7], s64 offen lds
    v_mfma_f32_32x32x16_bf16 v[80:95], v[100:103], v[112:115], v[80:95]
    s_waitcnt vmcnt(8)
    s_waitcnt lgkmcnt(0)
    s_barrier
    s_add_u32 s65, s58, 24576
    s_cmp_eq_u32 s65, 98304
    s_cselect_b32 s65, 0, s65
    v_add_u32 v143, s65, v142
    v_add_u32 v148, s60, v144
    v_mfma_f32_32x32x16_bf16 v[0:15], v[124:127], v[116:119], v[0:15]
    ds_read_b128 v[96:99], v148
    ds_read_b64_tr_b16 v[104:105], v143 offset:0
    ds_read_b64_tr_b16 v[106:107], v143 offset:256
    v_mfma_f32_32x32x16_bf16 v[16:31], v[124:127], v[120:123], v[16:31]
    ds_read_b128 v[100:103], v148 offset:4096
    ds_read_b64_tr_b16 v[108:109], v143 offset:4096
    ds_read_b64_tr_b16 v[110:111], v143 offset:4352
    v_mfma_f32_32x32x16_bf16 v[32:47], v[128:131], v[116:119], v[32:47]
    ds_read_b64_tr_b16 v[112:113], v143 offset:8192
    ds_read_b64_tr_b16 v[114:115], v143 offset:8448
    s_cmp_eq_u32 s54, 3
    s_cbranch_scc0 L_nogate_9
    v_dot2_f32_bf16 v140, v116, v136, v140
    v_dot2_f32_bf16 v141, v120, v136, v141
    v_dot2_f32_bf16 v140, v117, v137, v140
    v_dot2_f32_bf16 v141, v121, v137, v141
    v_dot2_f32_bf16 v140, v118, v138, v140
    v_dot2_f32_bf16 v141, v122, v138, v141
    v_dot2_f32_bf16 v140, v119, v139, v140
    v_dot2_f32_bf16 v141, v123, v139, v141
L_nogate_9:
    v_add_u32 v151, 128, v151
    ds_read_b128 v[136:139], v151
    v_mfma_f32_32x32x16_bf16 v[48:63], v[128:131], v[120:123], v[48:63]
    s_add_u32 s66, s56, s58
    s_add_u32 m0, s66, 0
    s_add_u32 s64, s62, 0
    buffer_load_dwordx4 v149, s[8:11], s64 offen lds
    s_add_u32 m0, s66, 4096
    s_add_u32 s64, s62, 2048
    buffer_load_dwordx4 v149, s[8:11], s64 offen lds
    v_mfma_f32_32x32x16_bf16 v[64:79], v[116:119], v[132:135], v[64:79]
    s_add_u32 m0, s66, 8192
    s_add_u32 s64, s62, 4096
    buffer_load_dwordx4 v149, s[8:11], s64 offen lds
    s_add_u32 m0, s57, s59
    s_lshl_b32 s64, s63, 7
    s_add_u32 s64, s64, 384
    buffer_load_dwordx4 v150, s[4:7], s64 offen lds
    s_add_u32 s62, s62, 0x30000
    s_mov_b32 s58, s65
    v_mfma_f32_32x32x16_bf16 v[80:95], v[120:123], v[132:135], v[80:95]
    s_waitcnt lgkmcnt(0)
    s_mov_b32 s64, s59
    s_mov_b32 s59, s60
    s_mov_b32 s60, s61
    s_mov_b32 s61, s64
    s_add_u32 s63, s63, 1
L_gemm:
    v_add_u32 v148, s59, v145
    v_mfma_f32_32x32x16_bf16 v[0:15], v[104:107], v[96:99], v[0:15]
    ds_read_b128 v[116:119], v148
    ds_read_b64_tr_b16 v[124:125], v143 offset:2048
    ds_read_b64_tr_b16 v[126:127], v143 offset:2304
    v_mfma_f32_32x32x16_bf16 v[16:31], v[104:107], v[100:103], v[16:31]
    ds_read_b128 v[120:123], v148 offset:4096
    ds_read_b64_tr_b16 v[128:129], v143 offset:6144
    ds_read_b64_tr_b16 v[130:131], v143 offset:6400
    v_mfma_f32_32x32x16_bf16 v[32:47], v[108:111], v[96:99], v[32:47]
    ds_read_b64_tr_b16 v[132:133], v143 offset:10240
    ds_read_b64_tr_b16 v[134:135], v143 offset:10496
    s_cmp_eq_u32 s54, 0
    s_cbranch_scc0 L_nogate_10
    v_dot2_f32_bf16 v140, v96, v136, v140
    v_dot2_f32_bf16 v141, v100, v136, v141
    v_dot2_f32_bf16 v140, v97, v137, v140
    v_dot2_f32_bf16 v141, v101, v137, v141
    v_dot2_f32_bf16 v140, v98, v138, v140
    v_dot2_f32_bf16 v141, v102, v138, v141
    v_dot2_f32_bf16 v140, v99, v139, v140
    v_dot2_f32_bf16 v141, v103, v139, v141
L_nogate_10:
    v_mfma_f32_32x32x16_bf16 v[48:63], v[108:111], v[100:103], v[48:63]
    v_mfma_f32_32x32x16_bf16 v[64:79], v[96:99], v[112:115], v[64:79]
    v_mfma_f32_32x32x16_bf16 v[80:95], v[100:103], v[112:115], v[80:95]
    s_waitcnt vmcnt(8) lgkmcnt(0)
    s_barrier
    s_add_u32 s65, s58, 24576
    s_cmp_eq_u32 s65, 98304
    s_cselect_b32 s65, 0, s65
    v_add_u32 v143, s65, v142
    v_add_u32 v148, s59, v146
    v_mfma_f32_32x32x16_bf16 v[0:15], v[124:127], v[116:119], v[0:15]
    ds_read_b128 v[96:99], v148
    ds_read_b64_tr_b16 v[104:105], v143 offset:0
    ds_read_b64_tr_b16 v[106:107], v143 offset:256
    v_mfma_f32_32x32x16_bf16 v[16:31], v[124:127], v[120:123], v[16:31]
    ds_read_b128 v[100:103], v148 offset:4096
    ds_read_b64_tr_b16 v[108:109], v143 offset:4096
    ds_read_b64_tr_b16 v[110:111], v143 offset:4352
    v_mfma_f32_32x32x16_bf16 v[32:47], v[128:131], v[116:119], v[32:47]
    ds_read_b64_tr_b16 v[112:113], v143 offset:8192
    ds_read_b64_tr_b16 v[114:115], v143 offset:8448
    s_cmp_eq_u32 s54, 1
    s_cbranch_scc0 L_nogate_12
    v_dot2_f32_bf16 v140, v116, v136, v140
    v_dot2_f32_bf16 v141, v120, v136, v141
    v_dot2_f32_bf16 v140, v117, v137, v140
    v_dot2_f32_bf16 v141, v121, v137, v141
    v_dot2_f32_bf16 v140, v118, v138, v140
    v_dot2_f32_bf16 v141, v122, v138, v141
    v_dot2_f32_bf16 v140, v119, v139, v140
    v_dot2_f32_bf16 v141, v123, v139, v141
L_nogate_12:
    v_mfma_f32_32x32x16_bf16 v[48:63], v[128:131], v[120:123], v[48:63]
    s_add_u32 s66, s56, s58
    s_add_u32 m0, s66, 0
    s_add_u32 s64, s62, 0
    buffer_load_dwordx4 v149, s[8:11], s64 offen lds
    s_add_u32 m0, s66, 4096
    s_add_u32 s64, s62, 2048
    buffer_load_dwordx4 v149, s[8:11], s64 offen lds
    v_mfma_f32_32x32x16_bf16 v[64:79], v[116:119], v[132:135], v[64:79]
    s_add_u32 m0, s66, 8192
    s_add_u32 s64, s62, 4096
    buffer_load_dwordx4 v149, s[8:11], s64 offen lds
    s_add_u32 s66, s57, s61
    s_add_u32 m0, s66, 8192
    s_lshl_b32 s64, s63, 7
    s_add_u32 s64, s64, 0x20100
    buffer_load_dwordx4 v150, s[4:7], s64 offen lds
    s_add_u32 s62, s62, 0x30000
    s_mov_b32 s58, s65
    s_cmp_eq_u32 s88, s63
    s_cbranch_scc0 L_pfj_11
    buffer_load_dword v164, v166, s[24:27], s89 offen
L_pfj_11:
    v_mfma_f32_32x32x16_bf16 v[80:95], v[120:123], v[132:135], v[80:95]
    s_waitcnt lgkmcnt(0)
    v_add_u32 v148, s59, v147
    v_mfma_f32_32x32x16_bf16 v[0:15], v[104:107], v[96:99], v[0:15]
    ds_read_b128 v[116:119], v148
    ds_read_b64_tr_b16 v[124:125], v143 offset:2048
    ds_read_b64_tr_b16 v[126:127], v143 offset:2304
    v_mfma_f32_32x32x16_bf16 v[16:31], v[104:107], v[100:103], v[16:31]
    ds_read_b128 v[120:123], v148 offset:4096
    ds_read_b64_tr_b16 v[128:129], v143 offset:6144
    ds_read_b64_tr_b16 v[130:131], v143 offset:6400
    v_mfma_f32_32x32x16_bf16 v[32:47], v[108:111], v[96:99], v[32:47]
    ds_read_b64_tr_b16 v[132:133], v143 offset:10240
    ds_read_b64_tr_b16 v[134:135], v143 offset:10496
    s_cmp_eq_u32 s54, 2
    s_cbranch_scc0 L_nogate_13
    v_dot2_f32_bf16 v140, v96, v136, v140
    v_dot2_f32_bf16 v141, v100, v136, v141
    v_dot2_f32_bf16 v140, v97, v137, v140
    v_dot2_f32_bf16 v141, v101, v137, v141
    v_dot2_f32_bf16 v140, v98, v138, v140
    v_dot2_f32_bf16 v141, v102, v138, v141
    v_dot2_f32_bf16 v140, v99, v139, v140
    v_dot2_f32_bf16 v141, v103, v139, v141
L_nogate_13:
    v_mfma_f32_32x32x16_bf16 v[48:63], v[108:111], v[100:103], v[48:63]
    v_mfma_f32_32x32x16_bf16 v[64:79], v[96:99], v[112:115], v[64:79]
    v_mfma_f32_32x32x16_bf16 v[80:95], v[100:103], v[112:115], v[80:95]
    s_waitcnt vmcnt(8) lgkmcnt(0)
    s_barrier
    s_add_u32 s65, s58, 24576
    s_cmp_eq_u32 s65, 98304
    s_cselect_b32 s65, 0, s65
    v_add_u32 v143, s65, v142
    v_add_u32 v148, s60, v144
    v_mfma_f32_32x32x16_bf16 v[0:15], v[124:127], v[116:119], v[0:15]
    ds_read_b128 v[96:99], v148
    ds_read_b64_tr_b16 v[104:105], v143 offset:0
    ds_read_b64_tr_b16 v[106:107], v143 offset:256
    v_mfma_f32_32x32x16_bf16 v[16:31], v[124:127], v[120:123], v[16:31]
    ds_read_b128 v[100:103], v148 offset:4096
    ds_read_b64_tr_b16 v[108:109], v143 offset:4096
    ds_read_b64_tr_b16 v[110:111], v143 offset:4352
    v_mfma_f32_32x32x16_bf16 v[32:47], v[128:131], v[116:119], v[32:47]
    ds_read_b64_tr_b16 v[112:113], v143 offset:8192
    ds_read_b64_tr_b16 v[114:115], v143 offset:8448
    s_cmp_eq_u32 s54, 3
    s_cbranch_scc0 L_nogate_14
    v_dot2_f32_bf16 v140, v116, v136, v140
    v_dot2_f32_bf16 v141, v120, v136, v141
    v_dot2_f32_bf16 v140, v117, v137, v140
    v_dot2_f32_bf16 v141, v121, v137, v141
    v_dot2_f32_bf16 v140, v118, v138, v140
    v_dot2_f32_bf16 v141, v122, v138, v141
    v_dot2_f32_bf16 v140, v119, v139, v140
    v_dot2_f32_bf16 v141, v123, v139, v141
L_nogate_14:
    v_add_u32 v151, 128, v151
    ds_read_b128 v[136:139], v151
    v_mfma_f32_32x32x16_bf16 v[48:63], v[128:131], v[120:123], v[48:63]
    s_add_u32 s66, s56, s58
    s_add_u32 m0, s66, 0
    s_add_u32 s64, s62, 0
    buffer_load_dwordx4 v149, s[8:11], s64 offen lds
    s_add_u32 m0, s66, 4096
    s_add_u32 s64, s62, 2048
    buffer_load_dwordx4 v149, s[8:11], s64 offen lds
    v_mfma_f32_32x32x16_bf16 v[64:79], v[116:119], v[132:135], v[64:79]
    s_add_u32 m0, s66, 8192
    s_add_u32 s64, s62, 4096
    buffer_load_dwordx4 v149, s[8:11], s64 offen lds
    s_add_u32 m0, s57, s59
    s_lshl_b32 s64, s63, 7
    s_add_u32 s64, s64, 384
    buffer_load_dwordx4 v150, s[4:7], s64 offen lds
    s_add_u32 s62, s62, 0x30000
    s_mov_b32 s58, s65
    v_mfma_f32_32x32x16_bf16 v[80:95], v[120:123], v[132:135], v[80:95]
    s_waitcnt lgkmcnt(0)
    s_mov_b32 s64, s59
    s_mov_b32 s59, s60
    s_mov_b32 s60, s61
    s_mov_b32 s61, s64
    s_add_u32 s63, s63, 1
    s_cmp_lt_u32 s63, 13
    s_cbranch_scc1 L_gemm
    v_add_u32 v148, s59, v145
    v_mfma_f32_32x32x16_bf16 v[0:15], v[104:107], v[96:99], v[0:15]
    ds_read_b128 v[116:119], v148
    ds_read_b64_tr_b16 v[124:125], v143 offset:2048
    ds_read_b64_tr_b16 v[126:127], v143 offset:2304
    v_mfma_f32_32x32x16_bf16 v[16:31], v[104:107], v[100:103], v[16:31]
    ds_read_b128 v[120:123], v148 offset:4096
    ds_read_b64_tr_b16 v[128:129], v143 offset:6144
    ds_read_b64_tr_b16 v[130:131], v143 offset:6400
    v_mfma_f32_32x32x16_bf16 v[32:47], v[108:111], v[96:99], v[32:47]
    ds_read_b64_tr_b16 v[132:133], v143 offset:10240
    ds_read_b64_tr_b16 v[134:135], v143 offset:10496
    s_cmp_eq_u32 s54, 0
    s_cbranch_scc0 L_nogate_15
    v_dot2_f32_bf16 v140, v96, v136, v140
    v_dot2_f32_bf16 v141, v100, v136, v141
    v_dot2_f32_bf16 v140, v97, v137, v140
    v_dot2_f32_bf16 v141, v101, v137, v141
    v_dot2_f32_bf16 v140, v98, v138, v140
    v_dot2_f32_bf16 v141, v102, v138, v141
    v_dot2_f32_bf16 v140, v99, v139, v140
    v_dot2_f32_bf16 v141, v103, v139, v141
L_nogate_15:
    v_mfma_f32_32x32x16_bf16 v[48:63], v[108:111], v[100:103], v[48:63]
    v_mfma_f32_32x32x16_bf16 v[64:79], v[96:99], v[112:115], v[64:79]
    v_mfma_f32_32x32x16_bf16 v[80:95], v[100:103], v[112:115], v[80:95]
    s_waitcnt vmcnt(8) lgkmcnt(0)
    s_barrier
    s_add_u32 s65, s58, 24576
    s_cmp_eq_u32 s65, 98304
    s_cselect_b32 s65, 0, s65
    v_add_u32 v143, s65, v142
    v_add_u32 v148, s59, v146
    v_mfma_f32_32x32x16_bf16 v[0:15], v[124:127], v[116:119], v[0:15]
    ds_read_b128 v[96:99], v148
    ds_read_b64_tr_b16 v[104:105], v143 offset:0
    ds_read_b64_tr_b16 v[106:107], v143 offset:256
    v_mfma_f32_32x32x16_bf16 v[16:31], v[124:127], v[120:123], v[16:31]
    ds_read_b128 v[100:103], v148 offset:4096
    ds_read_b64_tr_b16 v[108:109], v143 offset:4096
    ds_read_b64_tr_b16 v[110:111], v143 offset:4352
    v_mfma_f32_32x32x16_bf16 v[32:47], v[128:131], v[116:119], v[32:47]
    ds_read_b64_tr_b16 v[112:113], v143 offset:8192
    ds_read_b64_tr_b16 v[114:115], v143 offset:8448
    s_cmp_eq_u32 s54, 1
    s_cbranch_scc0 L_nogate_16
    v_dot2_f32_bf16 v140, v116, v136, v140
    v_dot2_f32_bf16 v141, v120, v136, v141
    v_dot2_f32_bf16 v140, v117, v137, v140
    v_dot2_f32_bf16 v141, v121, v137, v141
    v_dot2_f32_bf16 v140, v118, v138, v140
    v_dot2_f32_bf16 v141, v122, v138, v141
    v_dot2_f32_bf16 v140, v119, v139, v140
    v_dot2_f32_bf16 v141, v123, v139, v141
L_nogate_16:
    v_mfma_f32_32x32x16_bf16 v[48:63], v[128:131], v[120:123], v[48:63]
    s_add_u32 s66, s56, s58
    s_add_u32 m0, s66, 0
    s_add_u32 s64, s62, 0
    buffer_load_dwordx4 v149, s[8:11], s64 offen lds
    s_add_u32 m0, s66, 4096
    s_add_u32 s64, s62, 2048
    buffer_load_dwordx4 v149, s[8:11], s64 offen lds
    v_mfma_f32_32x32x16_bf16 v[64:79], v[116:119], v[132:135], v[64:79]
    s_add_u32 m0, s66, 8192
    s_add_u32 s64, s62, 4096
    buffer_load_dwordx4 v149, s[8:11], s64 offen lds
    s_add_u32 s66, s57, s61
    s_add_u32 m0, s66, 8192
    s_lshl_b32 s64, s63, 7
    s_add_u32 s64, s64, 0x20100
    buffer_load_dwordx4 v150, s[4:7], s64 offen lds
    s_add_u32 s62, s62, 0x30000
    s_mov_b32 s58, s65
    v_mfma_f32_32x32x16_bf16 v[80:95], v[120:123], v[132:135], v[80:95]
    s_waitcnt lgkmcnt(0)
    v_add_u32 v148, s59, v147
    v_mfma_f32_32x32x16_bf16 v[0:15], v[104:107], v[96:99], v[0:15]
    ds_read_b128 v[116:119], v148
    ds_read_b64_tr_b16 v[124:125], v143 offset:2048
    ds_read_b64_tr_b16 v[126:127], v143 offset:2304
    v_mfma_f32_32x32x16_bf16 v[16:31], v[104:107], v[100:103], v[16:31]
    ds_read_b128 v[120:123], v148 offset:4096
    ds_read_b64_tr_b16 v[128:129], v143 offset:6144
    ds_read_b64_tr_b16 v[130:131], v143 offset:6400
    v_mfma_f32_32x32x16_bf16 v[32:47], v[108:111], v[96:99], v[32:47]
    ds_read_b64_tr_b16 v[132:133], v143 offset:10240
    ds_read_b64_tr_b16 v[134:135], v143 offset:10496
    s_cmp_eq_u32 s54, 2
    s_cbranch_scc0 L_nogate_17
    v_dot2_f32_bf16 v140, v96, v136, v140
    v_dot2_f32_bf16 v141, v100, v136, v141
    v_dot2_f32_bf16 v140, v97, v137, v140
    v_dot2_f32_bf16 v141, v101, v137, v141
    v_dot2_f32_bf16 v140, v98, v138, v140
    v_dot2_f32_bf16 v141, v102, v138, v141
    v_dot2_f32_bf16 v140, v99, v139, v140
    v_dot2_f32_bf16 v141, v103, v139, v141
L_nogate_17:
    v_mfma_f32_32x32x16_bf16 v[48:63], v[108:111], v[100:103], v[48:63]
    v_mfma_f32_32x32x16_bf16 v[64:79], v[96:99], v[112:115], v[64:79]
    v_mfma_f32_32x32x16_bf16 v[80:95], v[100:103], v[112:115], v[80:95]
    s_waitcnt vmcnt(8) lgkmcnt(0)
    s_barrier
    s_add_u32 s65, s58, 24576
    s_cmp_eq_u32 s65, 98304
    s_cselect_b32 s65, 0, s65
    v_add_u32 v143, s65, v142
    v_add_u32 v148, s60, v144
    v_mfma_f32_32x32x16_bf16 v[0:15], v[124:127], v[116:119], v[0:15]
    ds_read_b128 v[96:99], v148
    ds_read_b64_tr_b16 v[104:105], v143 offset:0
    ds_read_b64_tr_b16 v[106:107], v143 offset:256
    v_mfma_f32_32x32x16_bf16 v[16:31], v[124:127], v[120:123], v[16:31]
    ds_read_b128 v[100:103], v148 offset:4096
    ds_read_b64_tr_b16 v[108:109], v143 offset:4096
    ds_read_b64_tr_b16 v[110:111], v143 offset:4352
    v_mfma_f32_32x32x16_bf16 v[32:47], v[128:131], v[116:119], v[32:47]
    ds_read_b64_tr_b16 v[112:113], v143 offset:8192
    ds_read_b64_tr_b16 v[114:115], v143 offset:8448
    s_cmp_eq_u32 s54, 3
    s_cbranch_scc0 L_nogate_18
    v_dot2_f32_bf16 v140, v116, v136, v140
    v_dot2_f32_bf16 v141, v120, v136, v141
    v_dot2_f32_bf16 v140, v117, v137, v140
    v_dot2_f32_bf16 v141, v121, v137, v141
    v_dot2_f32_bf16 v140, v118, v138, v140
    v_dot2_f32_bf16 v141, v122, v138, v141
    v_dot2_f32_bf16 v140, v119, v139, v140
    v_dot2_f32_bf16 v141, v123, v139, v141
L_nogate_18:
    v_add_u32 v151, 128, v151
    ds_read_b128 v[136:139], v151
    v_mfma_f32_32x32x16_bf16 v[48:63], v[128:131], v[120:123], v[48:63]
    s_add_u32 s66, s56, s58
    s_add_u32 m0, s66, 0
    s_add_u32 s64, s62, 0
    buffer_load_dwordx4 v149, s[8:11], s64 offen lds
    s_add_u32 m0, s66, 4096
    s_add_u32 s64, s62, 2048
    buffer_load_dwordx4 v149, s[8:11], s64 offen lds
    v_mfma_f32_32x32x16_bf16 v[64:79], v[116:119], v[132:135], v[64:79]
    s_add_u32 m0, s66, 8192
    s_add_u32 s64, s62, 4096
    buffer_load_dwordx4 v149, s[8:11], s64 offen lds
    s_add_u32 s62, s62, 0x30000
    s_mov_b32 s58, s65
    v_mfma_f32_32x32x16_bf16 v[80:95], v[120:123], v[132:135], v[80:95]
    s_waitcnt lgkmcnt(0)
    s_mov_b32 s64, s59
    s_mov_b32 s59, s60
    s_mov_b32 s60, s61
    s_mov_b32 s61, s64
    s_add_u32 s63, s63, 1
    v_add_u32 v148, s59, v145
    v_mfma_f32_32x32x16_bf16 v[0:15], v[104:107], v[96:99], v[0:15]
    ds_read_b128 v[116:119], v148
    ds_read_b64_tr_b16 v[124:125], v143 offset:2048
    ds_read_b64_tr_b16 v[126:127], v143 offset:2304
    v_mfma_f32_32x32x16_bf16 v[16:31], v[104:107], v[100:103], v[16:31]
    ds_read_b128 v[120:123], v148 offset:4096
    ds_read_b64_tr_b16 v[128:129], v143 offset:6144
    ds_read_b64_tr_b16 v[130:131], v143 offset:6400
    v_mfma_f32_32x32x16_bf16 v[32:47], v[108:111], v[96:99], v[32:47]
    ds_read_b64_tr_b16 v[132:133], v143 offset:10240
    ds_read_b64_tr_b16 v[134:135], v143 offset:10496
    s_cmp_eq_u32 s54, 0
    s_cbranch_scc0 L_nogate_19
    v_dot2_f32_bf16 v140, v96, v136, v140
    v_dot2_f32_bf16 v141, v100, v136, v141
    v_dot2_f32_bf16 v140, v97, v137, v140
    v_dot2_f32_bf16 v141, v101, v137, v141
    v_dot2_f32_bf16 v140, v98, v138, v140
    v_dot2_f32_bf16 v141, v102, v138, v141
    v_dot2_f32_bf16 v140, v99, v139, v140
    v_dot2_f32_bf16 v141, v103, v139, v141
L_nogate_19:
    v_mfma_f32_32x32x16_bf16 v[48:63], v[108:111], v[100:103], v[48:63]
    v_mfma_f32_32x32x16_bf16 v[64:79], v[96:99], v[112:115], v[64:79]
    v_mfma_f32_32x32x16_bf16 v[80:95], v[100:103], v[112:115], v[80:95]
    s_waitcnt vmcnt(7) lgkmcnt(0)
    s_barrier
    s_add_u32 s65, s58, 24576
    s_cmp_eq_u32 s65, 98304
    s_cselect_b32 s65, 0, s65
    v_add_u32 v143, s65, v142
    v_add_u32 v148, s59, v146
    v_mfma_f32_32x32x16_bf16 v[0:15], v[124:127], v[116:119], v[0:15]
    ds_read_b128 v[96:99], v148
    ds_read_b64_tr_b16 v[104:105], v143 offset:0
    ds_read_b64_tr_b16 v[106:107], v143 offset:256
    v_mfma_f32_32x32x16_bf16 v[16:31], v[124:127], v[120:123], v[16:31]
    ds_read_b128 v[100:103], v148 offset:4096
    ds_read_b64_tr_b16 v[108:109], v143 offset:4096
    ds_read_b64_tr_b16 v[110:111], v143 offset:4352
    v_mfma_f32_32x32x16_bf16 v[32:47], v[128:131], v[116:119], v[32:47]
    ds_read_b64_tr_b16 v[112:113], v143 offset:8192
    ds_read_b64_tr_b16 v[114:115], v143 offset:8448
    s_cmp_eq_u32 s54, 1
    s_cbranch_scc0 L_nogate_22
    v_dot2_f32_bf16 v140, v116, v136, v140
    v_dot2_f32_bf16 v141, v120, v136, v141
    v_dot2_f32_bf16 v140, v117, v137, v140
    v_dot2_f32_bf16 v141, v121, v137, v141
    v_dot2_f32_bf16 v140, v118, v138, v140
    v_dot2_f32_bf16 v141, v122, v138, v141
    v_dot2_f32_bf16 v140, v119, v139, v140
    v_dot2_f32_bf16 v141, v123, v139, v141
L_nogate_22:
    v_mfma_f32_32x32x16_bf16 v[48:63], v[128:131], v[120:123], v[48:63]
    v_mfma_f32_32x32x16_bf16 v[64:79], v[116:119], v[132:135], v[64:79]
    s_mov_b32 s58, s65
    s_cmp_eq_u32 s48, 4
    s_cbranch_scc1 L_dbgw_20
    buffer_load_dword v165, off, s[4:7], 0
    s_branch L_dbgx_21
L_dbgw_20:
    buffer_load_dword v165, off, s[20:23], 0 sc1
L_dbgx_21:
    v_mfma_f32_32x32x16_bf16 v[80:95], v[120:123], v[132:135], v[80:95]
    s_waitcnt lgkmcnt(0)
    v_add_u32 v148, s59, v147
    v_mfma_f32_32x32x16_bf16 v[0:15], v[104:107], v[96:99], v[0:15]
    ds_read_b128 v[116:119], v148
    ds_read_b64_tr_b16 v[124:125], v143 offset:2048
    ds_read_b64_tr_b16 v[126:127], v143 offset:2304
    v_mfma_f32_32x32x16_bf16 v[16:31], v[104:107], v[100:103], v[16:31]
    ds_read_b128 v[120:123], v148 offset:4096
    ds_read_b64_tr_b16 v[128:129], v143 offset:6144
    ds_read_b64_tr_b16 v[130:131], v143 offset:6400
    v_mfma_f32_32x32x16_bf16 v[32:47], v[108:111], v[96:99], v[32:47]
    ds_read_b64_tr_b16 v[132:133], v143 offset:10240
    ds_read_b64_tr_b16 v[134:135], v143 offset:10496
    s_cmp_eq_u32 s54, 2
    s_cbranch_scc0 L_nogate_23
    v_dot2_f32_bf16 v140, v96, v136, v140
    v_dot2_f32_bf16 v141, v100, v136, v141
    v_dot2_f32_bf16 v140, v97, v137, v140
    v_dot2_f32_bf16 v141, v101, v137, v141
    v_dot2_f32_bf16 v140, v98, v138, v140
    v_dot2_f32_bf16 v141, v102, v138, v141
    v_dot2_f32_bf16 v140, v99, v139, v140
    v_dot2_f32_bf16 v141, v103, v139, v141
L_nogate_23:
    v_mfma_f32_32x32x16_bf16 v[48:63], v[108:111], v[100:103], v[48:63]
    v_mfma_f32_32x32x16_bf16 v[64:79], v[96:99], v[112:115], v[64:79]
    v_mfma_f32_32x32x16_bf16 v[80:95], v[100:103], v[112:115], v[80:95]
    s_waitcnt vmcnt(4) lgkmcnt(0)
    s_barrier
    s_add_u32 s65, s58, 24576
    s_cmp_eq_u32 s65, 98304
    s_cselect_b32 s65, 0, s65
    v_add_u32 v143, s65, v142
    v_add_u32 v148, s60, v144
    v_mfma_f32_32x32x16_bf16 v[0:15], v[124:127], v[116:119], v[0:15]
    ds_read_b128 v[96:99], v148
    ds_read_b64_tr_b16 v[104:105], v143 offset:0
    ds_read_b64_tr_b16 v[106:107], v143 offset:256
    v_mfma_f32_32x32x16_bf16 v[16:31], v[124:127], v[120:123], v[16:31]
    ds_read_b128 v[100:103], v148 offset:4096
    ds_read_b64_tr_b16 v[108:109], v143 offset:4096
    ds_read_b64_tr_b16 v[110:111], v143 offset:4352
    v_mfma_f32_32x32x16_bf16 v[32:47], v[128:131], v[116:119], v[32:47]
    ds_read_b64_tr_b16 v[112:113], v143 offset:8192
    ds_read_b64_tr_b16 v[114:115], v143 offset:8448
    s_cmp_eq_u32 s54, 3
    s_cbranch_scc0 L_nogate_24
    v_dot2_f32_bf16 v140, v116, v136, v140
    v_dot2_f32_bf16 v141, v120, v136, v141
    v_dot2_f32_bf16 v140, v117, v137, v140
    v_dot2_f32_bf16 v141, v121, v137, v141
    v_dot2_f32_bf16 v140, v118, v138, v140
    v_dot2_f32_bf16 v141, v122, v138, v141
    v_dot2_f32_bf16 v140, v119, v139, v140
    v_dot2_f32_bf16 v141, v123, v139, v141
L_nogate_24:
    v_add_u32 v151, 128, v151
    ds_read_b128 v[136:139], v151
    v_mfma_f32_32x32x16_bf16 v[48:63], v[128:131], v[120:123], v[48:63]
    v_mfma_f32_32x32x16_bf16 v[64:79], v[116:119], v[132:135], v[64:79]
    s_mov_b32 s58, s65
    v_mfma_f32_32x32x16_bf16 v[80:95], v[120:123], v[132:135], v[80:95]
    s_waitcnt lgkmcnt(0)
    s_mov_b32 s64, s59
    s_mov_b32 s59, s60
    s_mov_b32 s60, s61
    s_mov_b32 s61, s64
    s_add_u32 s63, s63, 1
    v_add_u32 v148, s59, v145
    v_mfma_f32_32x32x16_bf16 v[0:15], v[104:107], v[96:99], v[0:15]
    ds_read_b128 v[116:119], v148
    ds_read_b64_tr_b16 v[124:125], v143 offset:2048
    ds_read_b64_tr_b16 v[126:127], v143 offset:2304
    v_mfma_f32_32x32x16_bf16 v[16:31], v[104:107], v[100:103], v[16:31]
    ds_read_b128 v[120:123], v148 offset:4096
    ds_read_b64_tr_b16 v[128:129], v143 offset:6144
    ds_read_b64_tr_b16 v[130:131], v143 offset:6400
    v_mfma_f32_32x32x16_bf16 v[32:47], v[108:111], v[96:99], v[32:47]
    ds_read_b64_tr_b16 v[132:133], v143 offset:10240
    ds_read_b64_tr_b16 v[134:135], v143 offset:10496
    s_cmp_eq_u32 s54, 0
    s_cbranch_scc0 L_nogate_25
    v_dot2_f32_bf16 v140, v96, v136, v140
    v_dot2_f32_bf16 v141, v100, v136, v141
    v_dot2_f32_bf16 v140, v97, v137, v140
    v_dot2_f32_bf16 v141, v101, v137, v141
    v_dot2_f32_bf16 v140, v98, v138, v140
    v_dot2_f32_bf16 v141, v102, v138, v141
    v_dot2_f32_bf16 v140, v99, v139, v140
    v_dot2_f32_bf16 v141, v103, v139, v141
L_nogate_25:
    v_mfma_f32_32x32x16_bf16 v[48:63], v[108:111], v[100:103], v[48:63]
    v_mfma_f32_32x32x16_bf16 v[64:79], v[96:99], v[112:115], v[64:79]
    v_mfma_f32_32x32x16_bf16 v[80:95], v[100:103], v[112:115], v[80:95]
    s_waitcnt vmcnt(1) lgkmcnt(0)
    s_barrier
    s_add_u32 s65, s58, 24576
    s_cmp_eq_u32 s65, 98304
    s_cselect_b32 s65, 0, s65
    v_add_u32 v143, s65, v142
    v_add_u32 v148, s59, v146
    v_mfma_f32_32x32x16_bf16 v[0:15], v[124:127], v[116:119], v[0:15]
    ds_read_b128 v[96:99], v148
    ds_read_b64_tr_b16 v[104:105], v143 offset:0
    ds_read_b64_tr_b16 v[106:107], v143 offset:256
    v_mfma_f32_32x32x16_bf16 v[16:31], v[124:127], v[120:123], v[16:31]
    ds_read_b128 v[100:103], v148 offset:4096
    ds_read_b64_tr_b16 v[108:109], v143 offset:4096
    ds_read_b64_tr_b16 v[110:111], v143 offset:4352
    v_mfma_f32_32x32x16_bf16 v[32:47], v[128:131], v[116:119], v[32:47]
    ds_read_b64_tr_b16 v[112:113], v143 offset:8192
    ds_read_b64_tr_b16 v[114:115], v143 offset:8448
    s_cmp_eq_u32 s54, 1
    s_cbranch_scc0 L_nogate_26
    v_dot2_f32_bf16 v140, v116, v136, v140
    v_dot2_f32_bf16 v141, v120, v136, v141
    v_dot2_f32_bf16 v140, v117, v137, v140
    v_dot2_f32_bf16 v141, v121, v137, v141
    v_dot2_f32_bf16 v140, v118, v138, v140
    v_dot2_f32_bf16 v141, v122, v138, v141
    v_dot2_f32_bf16 v140, v119, v139, v140
    v_dot2_f32_bf16 v141, v123, v139, v141
L_nogate_26:
    v_mfma_f32_32x32x16_bf16 v[48:63], v[128:131], v[120:123], v[48:63]
    v_mfma_f32_32x32x16_bf16 v[64:79], v[116:119], v[132:135], v[64:79]
    s_mov_b32 s58, s65
    v_mfma_f32_32x32x16_bf16 v[80:95], v[120:123], v[132:135], v[80:95]
    s_waitcnt lgkmcnt(0)
    v_add_u32 v148, s59, v147
    v_mfma_f32_32x32x16_bf16 v[0:15], v[104:107], v[96:99], v[0:15]
    ds_read_b128 v[116:119], v148
    ds_read_b64_tr_b16 v[124:125], v143 offset:2048
    ds_read_b64_tr_b16 v[126:127], v143 offset:2304
    v_mfma_f32_32x32x16_bf16 v[16:31], v[104:107], v[100:103], v[16:31]
    ds_read_b128 v[120:123], v148 offset:4096
    ds_read_b64_tr_b16 v[128:129], v143 offset:6144
    ds_read_b64_tr_b16 v[130:131], v143 offset:6400
    v_mfma_f32_32x32x16_bf16 v[32:47], v[108:111], v[96:99], v[32:47]
    ds_read_b64_tr_b16 v[132:133], v143 offset:10240
    ds_read_b64_tr_b16 v[134:135], v143 offset:10496
    s_cmp_eq_u32 s54, 2
    s_cbranch_scc0 L_nogate_27
    v_dot2_f32_bf16 v140, v96, v136, v140
    v_dot2_f32_bf16 v141, v100, v136, v141
    v_dot2_f32_bf16 v140, v97, v137, v140
    v_dot2_f32_bf16 v141, v101, v137, v141
    v_dot2_f32_bf16 v140, v98, v138, v140
    v_dot2_f32_bf16 v141, v102, v138, v141
    v_dot2_f32_bf16 v140, v99, v139, v140
    v_dot2_f32_bf16 v141, v103, v139, v141
L_nogate_27:
    v_mfma_f32_32x32x16_bf16 v[48:63], v[108:111], v[100:103], v[48:63]
    v_mfma_f32_32x32x16_bf16 v[64:79], v[96:99], v[112:115], v[64:79]
    v_mfma_f32_32x32x16_bf16 v[80:95], v[100:103], v[112:115], v[80:95]
    s_waitcnt lgkmcnt(0)
    v_mfma_f32_32x32x16_bf16 v[0:15], v[124:127], v[116:119], v[0:15]
    v_mfma_f32_32x32x16_bf16 v[16:31], v[124:127], v[120:123], v[16:31]
    v_mfma_f32_32x32x16_bf16 v[32:47], v[128:131], v[116:119], v[32:47]
    s_cmp_eq_u32 s54, 3
    s_cbranch_scc0 L_nogate_28
    v_dot2_f32_bf16 v140, v116, v136, v140
    v_dot2_f32_bf16 v141, v120, v136, v141
    v_dot2_f32_bf16 v140, v117, v137, v140
    v_dot2_f32_bf16 v141, v121, v137, v141
    v_dot2_f32_bf16 v140, v118, v138, v140
    v_dot2_f32_bf16 v141, v122, v138, v141
    v_dot2_f32_bf16 v140, v119, v139, v140
    v_dot2_f32_bf16 v141, v123, v139, v141
L_nogate_28:
    v_mfma_f32_32x32x16_bf16 v[48:63], v[128:131], v[120:123], v[48:63]
    v_mfma_f32_32x32x16_bf16 v[64:79], v[116:119], v[132:135], v[64:79]
    v_mfma_f32_32x32x16_bf16 v[80:95], v[120:123], v[132:135], v[80:95]
    v_permlane32_swap_b32 v140, v141
    s_lshl_b32 s64, s51, 8
    s_lshl_b32 s65, s54, 9
    s_add_u32 s64, s64, s65
    s_add_u32 s64, s64, 0x25000
    v_lshl_add_u32 v155, v253, 2, s64
    v_add_f32 v140, v140, v141
    ds_write_b32 v155, v140
    s_cmp_eq_u32 s49, 1
    s_cbranch_scc1 L_epiB
L_epiA:
    s_lshl_b32 s64, s2, 2
    s_and_b32 s65, s48, 3
    s_add_u32 s64, s64, s65
    s_cmp_ge_u32 s64, 512
    s_cselect_b32 s24, s38, s34
    s_cselect_b32 s25, s39, s35
    s_mov_b32 s26, 0x200000
    s_mov_b32 s27, 0x20000
    s_and_b32 s64, s64, 511
    s_lshl_b32 s64, s64, 12
    v_lshlrev_b32 v155, 7, v253
    s_mov_b32 exec_hi, 0
    buffer_load_dword v164, v155, s[24:27], s64 offen
    s_mov_b64 exec, -1
    v_cvt_pk_bf16_f32 v96, v0, v1
    v_cvt_pk_bf16_f32 v97, v2, v3
    v_cvt_pk_bf16_f32 v98, v4, v5
    v_cvt_pk_bf16_f32 v99, v6, v7
    v_cvt_pk_bf16_f32 v100, v8, v9
    v_cvt_pk_bf16_f32 v101, v10, v11
    v_cvt_pk_bf16_f32 v102, v12, v13
    v_cvt_pk_bf16_f32 v103, v14, v15
    v_cvt_pk_bf16_f32 v104, v16, v17
    v_cvt_pk_bf16_f32 v105, v18, v19
    v_cvt_pk_bf16_f32 v106, v20, v21
    v_cvt_pk_bf16_f32 v107, v22, v23
    v_cvt_pk_bf16_f32 v108, v24, v25
    v_cvt_pk_bf16_f32 v109, v26, v27
    v_cvt_pk_bf16_f32 v110, v28, v29
    v_cvt_pk_bf16_f32 v111, v30, v31
    s_lshl_b32 s64, s50, 1
    s_add_u32 s64, s64, s51
    s_lshl_b32 s65, s64, 13
    s_add_u32 s65, s65, 0x4000
    v_add_u32 v157, s65, v254
    s_lshl_b32 s64, s64, 2
    s_add_u32 s64, s64, 0x27880
    v_mov_b32 v158, s64
    ds_write_b128 v157, v[96:99] offset:0
    ds_write_b128 v157, v[100:103] offset:1024
    ds_write_b128 v157, v[104:107] offset:2048
    ds_write_b128 v157, v[108:111] offset:3072
    v_bfe_u32 v155, v253, 2, 2
    v_lshlrev_b32 v155, 6, v155
    v_bfe_u32 v156, v253, 4, 1
    v_lshl_add_u32 v155, v156, 5, v155
    v_and_b32 v156, 3, v253
    v_lshl_add_u32 v155, v156, 3, v155
    v_lshl_add_u32 v155, v255, 8, v155
    s_lshl_b32 s64, s50, 11
    s_add_u32 s64, s64, 0x24000
    v_add_u32 v155, s64, v155
    ds_read_b64_tr_b16 v[144:145], v155 offset:0
    ds_read_b64_tr_b16 v[146:147], v155 offset:512
    ds_read_b64_tr_b16 v[148:149], v155 offset:1024
    ds_read_b64_tr_b16 v[150:151], v155 offset:1536
    v_cvt_pk_bf16_f32 v112, v32, v33
    v_cvt_pk_bf16_f32 v113, v34, v35
    v_cvt_pk_bf16_f32 v114, v36, v37
    v_cvt_pk_bf16_f32 v115, v38, v39
    v_cvt_pk_bf16_f32 v116, v40, v41
    v_cvt_pk_bf16_f32 v117, v42, v43
    v_cvt_pk_bf16_f32 v118, v44, v45
    v_cvt_pk_bf16_f32 v119, v46, v47
    v_cvt_pk_bf16_f32 v120, v48, v49
    v_cvt_pk_bf16_f32 v121, v50, v51
    v_cvt_pk_bf16_f32 v122, v52, v53
    v_cvt_pk_bf16_f32 v123, v54, v55
    v_cvt_pk_bf16_f32 v124, v56, v57
    v_cvt_pk_bf16_f32 v125, v58, v59
    v_cvt_pk_bf16_f32 v126, v60, v61
    v_cvt_pk_bf16_f32 v127, v62, v63
    v_mov_b32 v155, 1
    s_waitcnt lgkmcnt(0)
    ds_write_b32 v158, v155
    v_cvt_pk_bf16_f32 v128, v64, v65
    v_cvt_pk_bf16_f32 v129, v66, v67
    v_cvt_pk_bf16_f32 v130, v68, v69
    v_cvt_pk_bf16_f32 v131, v70, v71
    v_cvt_pk_bf16_f32 v132, v72, v73
    v_cvt_pk_bf16_f32 v133, v74, v75
    v_cvt_pk_bf16_f32 v134, v76, v77
    v_cvt_pk_bf16_f32 v135, v78, v79
    v_cvt_pk_bf16_f32 v136, v80, v81
    v_cvt_pk_bf16_f32 v137, v82, v83
    v_cvt_pk_bf16_f32 v138, v84, v85
    v_cvt_pk_bf16_f32 v139, v86, v87
    v_cvt_pk_bf16_f32 v140, v88, v89
    v_cvt_pk_bf16_f32 v141, v90, v91
    v_cvt_pk_bf16_f32 v142, v92, v93
    v_cvt_pk_bf16_f32 v143, v94, v95
    v_and_b32 v160, 31, v253
    v_lshlrev_b32 v161, 2, v255
    v_sub_u32 v160, v160, v161
    v_and_b32 v161, 1, v160
    v_lshlrev_b32 v161, 4, v161
    v_mov_b32 v162, 0x3f80
    v_lshlrev_b32 v161, v161, v162
    v_ashrrev_i32 v160, 1, v160
    v_cmp_eq_u32 vcc, 0, v160
    s_nop 1
    v_cndmask_b32 v166, 0, v161, vcc
    v_cmp_eq_u32 vcc, 1, v160
    s_nop 1
    v_cndmask_b32 v167, 0, v161, vcc
    v_cmp_eq_u32 vcc, 4, v160
    s_nop 1
    v_cndmask_b32 v168, 0, v161, vcc
    v_cmp_eq_u32 vcc, 5, v160
    s_nop 1
    v_cndmask_b32 v169, 0, v161, vcc
    v_cmp_eq_u32 vcc, 8, v160
    s_nop 1
    v_cndmask_b32 v170, 0, v161, vcc
    v_cmp_eq_u32 vcc, 9, v160
    s_nop 1
    v_cndmask_b32 v171, 0, v161, vcc
    v_cmp_eq_u32 vcc, 12, v160
    s_nop 1
    v_cndmask_b32 v172, 0, v161, vcc
    v_cmp_eq_u32 vcc, 13, v160
    s_nop 1
    v_cndmask_b32 v173, 0, v161, vcc
    v_lshrrev_b32 v160, 2, v253
    v_lshrrev_b32 v161, 4, v253
    v_xor_b32 v160, v160, v161
    v_and_b32 v160, 1, v160
    v_mov_b32 v161, 0x3f803f80
    v_cmp_eq_u32 vcc, 0, v160
    s_nop 1
    v_cndmask_b32 v174, 0, v161, vcc
    v_cndmask_b32 v175, 0, v161, vcc
    v_cndmask_b32 v176, 0, v161, vcc
    v_cndmask_b32 v177, 0, v161, vcc
    s_mul_i32 s64, s51, 0x80008000
    s_waitcnt lgkmcnt(0)
    v_xor_b32 v144, s64, v144
    v_xor_b32 v145, s64, v145
    v_xor_b32 v146, s64, v146
    v_xor_b32 v147, s64, v147
    v_xor_b32 v148, s64, v148
    v_xor_b32 v149, s64, v149
    v_xor_b32 v150, s64, v150
    v_xor_b32 v151, s64, v151
    v_mfma_f32_32x32x16_bf16 v[32:47], v[144:147], v[112:115], 0
    s_nop 0
    v_mfma_f32_32x32x16_bf16 v[32:47], v[148:151], v[116:119], v[32:47]
    v_mfma_f32_32x32x16_bf16 v[48:63], v[144:147], v[120:123], 0
    v_mfma_f32_32x32x16_bf16 v[48:63], v[148:151], v[124:127], v[48:63]
    s_nop 9
    v_max3_f32 v160, v32, v33, v34
    v_max3_f32 v161, -v32, -v33, -v34
    v_max3_f32 v160, v160, v35, v36
    v_max3_f32 v161, v161, -v35, -v36
    v_max3_f32 v160, v160, v37, v38
    v_max3_f32 v161, v161, -v37, -v38
    v_max3_f32 v160, v160, v39, v40
    v_max3_f32 v161, v161, -v39, -v40
    v_max3_f32 v160, v160, v41, v42
    v_max3_f32 v161, v161, -v41, -v42
    v_max3_f32 v160, v160, v43, v44
    v_max3_f32 v161, v161, -v43, -v44
    v_max3_f32 v160, v160, v45, v46
    v_max3_f32 v161, v161, -v45, -v46
    v_max_f32 v160, v160, v47
    v_max_f32_e64 v161, v161, -v47
    s_nop 1
    v_permlane32_swap_b32 v160, v161
    v_max_f32 v160, v160, v161
    v_mov_b32 v161, v160
    s_nop 1
    v_permlane32_swap_b32 v160, v161
    v_mul_f32 v160, s69, v160
    v_mul_f32 v161, s69, v161
    v_fma_f32 v186, v32, s69, -v160
    v_fma_f32 v32, v32, -s69, -v161
    v_fma_f32 v187, v33, s69, -v160
    v_fma_f32 v33, v33, -s69, -v161
    v_fma_f32 v188, v34, s69, -v160
    v_fma_f32 v34, v34, -s69, -v161
    v_fma_f32 v189, v35, s69, -v160
    v_fma_f32 v35, v35, -s69, -v161
    v_fma_f32 v190, v36, s69, -v160
    v_fma_f32 v36, v36, -s69, -v161
    v_fma_f32 v191, v37, s69, -v160
    v_fma_f32 v37, v37, -s69, -v161
    v_fma_f32 v192, v38, s69, -v160
    v_fma_f32 v38, v38, -s69, -v161
    v_fma_f32 v193, v39, s69, -v160
    v_fma_f32 v39, v39, -s69, -v161
    v_fma_f32 v194, v40, s69, -v160
    v_fma_f32 v40, v40, -s69, -v161
    v_fma_f32 v195, v41, s69, -v160
    v_fma_f32 v41, v41, -s69, -v161
    v_fma_f32 v196, v42, s69, -v160
    v_fma_f32 v42, v42, -s69, -v161
    v_fma_f32 v197, v43, s69, -v160
    v_fma_f32 v43, v43, -s69, -v161
    v_fma_f32 v198, v44, s69, -v160
    v_fma_f32 v44, v44, -s69, -v161
    v_fma_f32 v199, v45, s69, -v160
    v_fma_f32 v45, v45, -s69, -v161
    v_fma_f32 v200, v46, s69, -v160
    v_fma_f32 v46, v46, -s69, -v161
    v_fma_f32 v201, v47, s69, -v160
    v_fma_f32 v47, v47, -s69, -v161
    v_exp_f32 v186, v186
    v_exp_f32 v32, v32
    v_exp_f32 v187, v187
    v_exp_f32 v33, v33
    v_exp_f32 v188, v188
    v_exp_f32 v34, v34
    v_exp_f32 v189, v189
    v_exp_f32 v35, v35
    v_exp_f32 v190, v190
    v_exp_f32 v36, v36
    v_exp_f32 v191, v191
    v_exp_f32 v37, v37
    v_exp_f32 v192, v192
    v_exp_f32 v38, v38
    v_exp_f32 v193, v193
    v_exp_f32 v39, v39
    v_exp_f32 v194, v194
    v_exp_f32 v40, v40
    v_exp_f32 v195, v195
    v_exp_f32 v41, v41
    v_exp_f32 v196, v196
    v_exp_f32 v42, v42
    v_exp_f32 v197, v197
    v_exp_f32 v43, v43
    v_exp_f32 v198, v198
    v_exp_f32 v44, v44
    v_exp_f32 v199, v199
    v_exp_f32 v45, v45
    v_exp_f32 v200, v200
    v_exp_f32 v46, v46
    v_exp_f32 v201, v201
    v_exp_f32 v47, v47
    v_add_f32 v162, v186, v187
    v_add_f32 v163, v32, v33
    v_add_f32 v162, v162, v188
    v_add_f32 v163, v163, v34
    v_add_f32 v162, v162, v189
    v_add_f32 v163, v163, v35
    v_add_f32 v162, v162, v190
    v_add_f32 v163, v163, v36
    v_add_f32 v162, v162, v191
    v_add_f32 v163, v163, v37
    v_add_f32 v162, v162, v192
    v_add_f32 v163, v163, v38
    v_add_f32 v162, v162, v193
    v_add_f32 v163, v163, v39
    v_add_f32 v162, v162, v194
    v_add_f32 v163, v163, v40
    v_add_f32 v162, v162, v195
    v_add_f32 v163, v163, v41
    v_add_f32 v162, v162, v196
    v_add_f32 v163, v163, v42
    v_add_f32 v162, v162, v197
    v_add_f32 v163, v163, v43
    v_add_f32 v162, v162, v198
    v_add_f32 v163, v163, v44
    v_add_f32 v162, v162, v199
    v_add_f32 v163, v163, v45
    v_add_f32 v162, v162, v200
    v_add_f32 v163, v163, v46
    v_add_f32 v162, v162, v201
    v_add_f32 v163, v163, v47
    s_nop 1
    v_permlane32_swap_b32 v162, v163
    v_add_f32 v162, v162, v163
    v_mov_b32 v163, v162
    s_nop 1
    v_permlane32_swap_b32 v162, v163
    v_rcp_f32 v162, v162
    v_rcp_f32 v163, v163
    v_mul_f32 v186, v186, v162
    v_mul_f32 v32, v32, v163
    v_mul_f32 v187, v187, v162
    v_mul_f32 v33, v33, v163
    v_mul_f32 v188, v188, v162
    v_mul_f32 v34, v34, v163
    v_mul_f32 v189, v189, v162
    v_mul_f32 v35, v35, v163
    v_mul_f32 v190, v190, v162
    v_mul_f32 v36, v36, v163
    v_mul_f32 v191, v191, v162
    v_mul_f32 v37, v37, v163
    v_mul_f32 v192, v192, v162
    v_mul_f32 v38, v38, v163
    v_mul_f32 v193, v193, v162
    v_mul_f32 v39, v39, v163
    v_mul_f32 v194, v194, v162
    v_mul_f32 v40, v40, v163
    v_mul_f32 v195, v195, v162
    v_mul_f32 v41, v41, v163
    v_mul_f32 v196, v196, v162
    v_mul_f32 v42, v42, v163
    v_mul_f32 v197, v197, v162
    v_mul_f32 v43, v43, v163
    v_mul_f32 v198, v198, v162
    v_mul_f32 v44, v44, v163
    v_mul_f32 v199, v199, v162
    v_mul_f32 v45, v45, v163
    v_mul_f32 v200, v200, v162
    v_mul_f32 v46, v46, v163
    v_mul_f32 v201, v201, v162
    v_mul_f32 v47, v47, v163
    v_cvt_pk_bf16_f32 v202, v186, v187
    v_cvt_pk_bf16_f32 v210, v32, v33
    v_cvt_pk_bf16_f32 v203, v188, v189
    v_cvt_pk_bf16_f32 v211, v34, v35
    v_cvt_pk_bf16_f32 v204, v190, v191
    v_cvt_pk_bf16_f32 v212, v36, v37
    v_cvt_pk_bf16_f32 v205, v192, v193
    v_cvt_pk_bf16_f32 v213, v38, v39
    v_cvt_pk_bf16_f32 v206, v194, v195
    v_cvt_pk_bf16_f32 v214, v40, v41
    v_cvt_pk_bf16_f32 v207, v196, v197
    v_cvt_pk_bf16_f32 v215, v42, v43
    v_cvt_pk_bf16_f32 v208, v198, v199
    v_cvt_pk_bf16_f32 v216, v44, v45
    v_cvt_pk_bf16_f32 v209, v200, v201
    v_cvt_pk_bf16_f32 v217, v46, v47
    v_mfma_f32_32x32x16_bf16 v[218:233], v[202:205], v[166:169], 0
    v_mfma_f32_32x32x16_bf16 v[234:249], v[210:213], v[166:169], 0
    v_mfma_f32_32x32x16_bf16 v[218:233], v[206:209], v[170:173], v[218:233]
    v_mfma_f32_32x32x16_bf16 v[234:249], v[214:217], v[170:173], v[234:249]
    s_nop 10
    v_cvt_pk_bf16_f32 v202, v218, v219
    v_cvt_pk_bf16_f32 v203, v220, v221
    v_cvt_pk_bf16_f32 v204, v222, v223
    v_cvt_pk_bf16_f32 v205, v224, v225
    v_cvt_pk_bf16_f32 v206, v226, v227
    v_cvt_pk_bf16_f32 v207, v228, v229
    v_cvt_pk_bf16_f32 v208, v230, v231
    v_cvt_pk_bf16_f32 v209, v232, v233
    v_cvt_pk_bf16_f32 v210, v234, v235
    v_cvt_pk_bf16_f32 v211, v236, v237
    v_cvt_pk_bf16_f32 v212, v238, v239
    v_cvt_pk_bf16_f32 v213, v240, v241
    v_cvt_pk_bf16_f32 v214, v242, v243
    v_cvt_pk_bf16_f32 v215, v244, v245
    v_cvt_pk_bf16_f32 v216, v246, v247
    v_cvt_pk_bf16_f32 v217, v248, v249
    v_mfma_f32_32x32x16_bf16 v[64:79], v[128:131], v[202:205], 0
    v_mfma_f32_32x32x16_bf16 v[80:95], v[128:131], v[210:213], 0
    v_mfma_f32_32x32x16_bf16 v[64:79], v[132:135], v[206:209], v[64:79]
    v_mfma_f32_32x32x16_bf16 v[80:95], v[132:135], v[214:217], v[80:95]
    v_mfma_f32_16x16x32_bf16 v[178:181], v[174:177], v[202:205], 0
    v_mfma_f32_16x16x32_bf16 v[182:185], v[174:177], v[210:213], 0
    v_mfma_f32_16x16x32_bf16 v[178:181], v[174:177], v[206:209], v[178:181]
    v_mfma_f32_16x16x32_bf16 v[182:185], v[174:177], v[214:217], v[182:185]
    v_max3_f32 v160, v48, v49, v50
    v_max3_f32 v161, -v48, -v49, -v50
    v_max3_f32 v160, v160, v51, v52
    v_max3_f32 v161, v161, -v51, -v52
    v_max3_f32 v160, v160, v53, v54
    v_max3_f32 v161, v161, -v53, -v54
    v_max3_f32 v160, v160, v55, v56
    v_max3_f32 v161, v161, -v55, -v56
    v_max3_f32 v160, v160, v57, v58
    v_max3_f32 v161, v161, -v57, -v58
    v_max3_f32 v160, v160, v59, v60
    v_max3_f32 v161, v161, -v59, -v60
    v_max3_f32 v160, v160, v61, v62
    v_max3_f32 v161, v161, -v61, -v62
    v_max_f32 v160, v160, v63
    v_max_f32_e64 v161, v161, -v63
    s_nop 1
    v_permlane32_swap_b32 v160, v161
    v_max_f32 v160, v160, v161
    v_mov_b32 v161, v160
    s_nop 1
    v_permlane32_swap_b32 v160, v161
    v_mul_f32 v160, s69, v160
    v_mul_f32 v161, s69, v161
    v_fma_f32 v186, v48, s69, -v160
    v_fma_f32 v48, v48, -s69, -v161
    v_fma_f32 v187, v49, s69, -v160
    v_fma_f32 v49, v49, -s69, -v161
    v_fma_f32 v188, v50, s69, -v160
    v_fma_f32 v50, v50, -s69, -v161
    v_fma_f32 v189, v51, s69, -v160
    v_fma_f32 v51, v51, -s69, -v161
    v_fma_f32 v190, v52, s69, -v160
    v_fma_f32 v52, v52, -s69, -v161
    v_fma_f32 v191, v53, s69, -v160
    v_fma_f32 v53, v53, -s69, -v161
    v_fma_f32 v192, v54, s69, -v160
    v_fma_f32 v54, v54, -s69, -v161
    v_fma_f32 v193, v55, s69, -v160
    v_fma_f32 v55, v55, -s69, -v161
    v_fma_f32 v194, v56, s69, -v160
    v_fma_f32 v56, v56, -s69, -v161
    v_fma_f32 v195, v57, s69, -v160
    v_fma_f32 v57, v57, -s69, -v161
    v_fma_f32 v196, v58, s69, -v160
    v_fma_f32 v58, v58, -s69, -v161
    v_fma_f32 v197, v59, s69, -v160
    v_fma_f32 v59, v59, -s69, -v161
    v_fma_f32 v198, v60, s69, -v160
    v_fma_f32 v60, v60, -s69, -v161
    v_fma_f32 v199, v61, s69, -v160
    v_fma_f32 v61, v61, -s69, -v161
    v_fma_f32 v200, v62, s69, -v160
    v_fma_f32 v62, v62, -s69, -v161
    v_fma_f32 v201, v63, s69, -v160
    v_fma_f32 v63, v63, -s69, -v161
    v_exp_f32 v186, v186
    v_exp_f32 v48, v48
    v_exp_f32 v187, v187
    v_exp_f32 v49, v49
    v_exp_f32 v188, v188
    v_exp_f32 v50, v50
    v_exp_f32 v189, v189
    v_exp_f32 v51, v51
    v_exp_f32 v190, v190
    v_exp_f32 v52, v52
    v_exp_f32 v191, v191
    v_exp_f32 v53, v53
    v_exp_f32 v192, v192
    v_exp_f32 v54, v54
    v_exp_f32 v193, v193
    v_exp_f32 v55, v55
    v_exp_f32 v194, v194
    v_exp_f32 v56, v56
    v_exp_f32 v195, v195
    v_exp_f32 v57, v57
    v_exp_f32 v196, v196
    v_exp_f32 v58, v58
    v_exp_f32 v197, v197
    v_exp_f32 v59, v59
    v_exp_f32 v198, v198
    v_exp_f32 v60, v60
    v_exp_f32 v199, v199
    v_exp_f32 v61, v61
    v_exp_f32 v200, v200
    v_exp_f32 v62, v62
    v_exp_f32 v201, v201
    v_exp_f32 v63, v63
    v_add_f32 v162, v186, v187
    v_add_f32 v163, v48, v49
    v_add_f32 v162, v162, v188
    v_add_f32 v163, v163, v50
    v_add_f32 v162, v162, v189
    v_add_f32 v163, v163, v51
    v_add_f32 v162, v162, v190
    v_add_f32 v163, v163, v52
    v_add_f32 v162, v162, v191
    v_add_f32 v163, v163, v53
    v_add_f32 v162, v162, v192
    v_add_f32 v163, v163, v54
    v_add_f32 v162, v162, v193
    v_add_f32 v163, v163, v55
    v_add_f32 v162, v162, v194
    v_add_f32 v163, v163, v56
    v_add_f32 v162, v162, v195
    v_add_f32 v163, v163, v57
    v_add_f32 v162, v162, v196
    v_add_f32 v163, v163, v58
    v_add_f32 v162, v162, v197
    v_add_f32 v163, v163, v59
    v_add_f32 v162, v162, v198
    v_add_f32 v163, v163, v60
    v_add_f32 v162, v162, v199
    v_add_f32 v163, v163, v61
    v_add_f32 v162, v162, v200
    v_add_f32 v163, v163, v62
    v_add_f32 v162, v162, v201
    v_add_f32 v163, v163, v63
    s_nop 1
    v_permlane32_swap_b32 v162, v163
    v_add_f32 v162, v162, v163
    v_mov_b32 v163, v162
    s_nop 1
    v_permlane32_swap_b32 v162, v163
    v_rcp_f32 v162, v162
    v_rcp_f32 v163, v163
    v_mul_f32 v186, v186, v162
    v_mul_f32 v48, v48, v163
    v_mul_f32 v187, v187, v162
    v_mul_f32 v49, v49, v163
    v_mul_f32 v188, v188, v162
    v_mul_f32 v50, v50, v163
    v_mul_f32 v189, v189, v162
    v_mul_f32 v51, v51, v163
    v_mul_f32 v190, v190, v162
    v_mul_f32 v52, v52, v163
    v_mul_f32 v191, v191, v162
    v_mul_f32 v53, v53, v163
    v_mul_f32 v192, v192, v162
    v_mul_f32 v54, v54, v163
    v_mul_f32 v193, v193, v162
    v_mul_f32 v55, v55, v163
    v_mul_f32 v194, v194, v162
    v_mul_f32 v56, v56, v163
    v_mul_f32 v195, v195, v162
    v_mul_f32 v57, v57, v163
    v_mul_f32 v196, v196, v162
    v_mul_f32 v58, v58, v163
    v_mul_f32 v197, v197, v162
    v_mul_f32 v59, v59, v163
    v_mul_f32 v198, v198, v162
    v_mul_f32 v60, v60, v163
    v_mul_f32 v199, v199, v162
    v_mul_f32 v61, v61, v163
    v_mul_f32 v200, v200, v162
    v_mul_f32 v62, v62, v163
    v_mul_f32 v201, v201, v162
    v_mul_f32 v63, v63, v163
    v_cvt_pk_bf16_f32 v202, v186, v187
    v_cvt_pk_bf16_f32 v210, v48, v49
    v_cvt_pk_bf16_f32 v203, v188, v189
    v_cvt_pk_bf16_f32 v211, v50, v51
    v_cvt_pk_bf16_f32 v204, v190, v191
    v_cvt_pk_bf16_f32 v212, v52, v53
    v_cvt_pk_bf16_f32 v205, v192, v193
    v_cvt_pk_bf16_f32 v213, v54, v55
    v_cvt_pk_bf16_f32 v206, v194, v195
    v_cvt_pk_bf16_f32 v214, v56, v57
    v_cvt_pk_bf16_f32 v207, v196, v197
    v_cvt_pk_bf16_f32 v215, v58, v59
    v_cvt_pk_bf16_f32 v208, v198, v199
    v_cvt_pk_bf16_f32 v216, v60, v61
    v_cvt_pk_bf16_f32 v209, v200, v201
    v_cvt_pk_bf16_f32 v217, v62, v63
    v_mfma_f32_32x32x16_bf16 v[218:233], v[202:205], v[166:169], 0
    v_mfma_f32_32x32x16_bf16 v[234:249], v[210:213], v[166:169], 0
    v_mfma_f32_32x32x16_bf16 v[218:233], v[206:209], v[170:173], v[218:233]
    v_mfma_f32_32x32x16_bf16 v[234:249], v[214:217], v[170:173], v[234:249]
    s_nop 10
    v_cvt_pk_bf16_f32 v202, v218, v219
    v_cvt_pk_bf16_f32 v203, v220, v221
    v_cvt_pk_bf16_f32 v204, v222, v223
    v_cvt_pk_bf16_f32 v205, v224, v225
    v_cvt_pk_bf16_f32 v206, v226, v227
    v_cvt_pk_bf16_f32 v207, v228, v229
    v_cvt_pk_bf16_f32 v208, v230, v231
    v_cvt_pk_bf16_f32 v209, v232, v233
    v_cvt_pk_bf16_f32 v210, v234, v235
    v_cvt_pk_bf16_f32 v211, v236, v237
    v_cvt_pk_bf16_f32 v212, v238, v239
    v_cvt_pk_bf16_f32 v213, v240, v241
    v_cvt_pk_bf16_f32 v214, v242, v243
    v_cvt_pk_bf16_f32 v215, v244, v245
    v_cvt_pk_bf16_f32 v216, v246, v247
    v_cvt_pk_bf16_f32 v217, v248, v249
    v_mfma_f32_32x32x16_bf16 v[64:79], v[136:139], v[202:205], v[64:79]
    v_mfma_f32_32x32x16_bf16 v[80:95], v[136:139], v[210:213], v[80:95]
    v_mfma_f32_32x32x16_bf16 v[64:79], v[140:143], v[206:209], v[64:79]
    v_mfma_f32_32x32x16_bf16 v[80:95], v[140:143], v[214:217], v[80:95]
    v_mfma_f32_16x16x32_bf16 v[178:181], v[174:177], v[202:205], v[178:181]
    v_mfma_f32_16x16x32_bf16 v[182:185], v[174:177], v[210:213], v[182:185]
    v_mfma_f32_16x16x32_bf16 v[178:181], v[174:177], v[206:209], v[178:181]
    v_mfma_f32_16x16x32_bf16 v[182:185], v[174:177], v[214:217], v[182:185]
    s_lshl_b32 s64, s50, 1
    s_xor_b32 s65, s51, 1
    s_add_u32 s64, s64, s65
    s_lshl_b32 s65, s64, 12
    s_add_u32 s65, s65, 0xc000
    v_add_u32 v155, s65, v254
    s_lshl_b32 s64, s64, 8
    s_add_u32 s64, s64, 0x10000
    v_lshlrev_b32 v156, 2, v253
    v_add_u32 v156, s64, v156
    ds_write_b128 v155, v[80:83] offset:0
    ds_write_b128 v155, v[84:87] offset:1024
    ds_write_b128 v155, v[88:91] offset:2048
    ds_write_b128 v155, v[92:95] offset:3072
    ds_write_b32 v156, v182
    s_waitcnt lgkmcnt(0)
    s_barrier
    s_lshl_b32 s64, s50, 1
    s_add_u32 s64, s64, s51
    s_lshl_b32 s65, s64, 12
    s_add_u32 s65, s65, 0xc000
    v_add_u32 v155, s65, v254
    s_lshl_b32 s65, s64, 8
    s_add_u32 s65, s65, 0x10000
    v_lshlrev_b32 v156, 2, v253
    v_add_u32 v156, s65, v156
    s_lshl_b32 s65, s64, 12
    s_add_u32 s65, s65, 75776
    v_add_u32 v157, s65, v254
    ds_read_b128 v[218:221], v155 offset:0
    ds_read_b128 v[222:225], v155 offset:1024
    ds_read_b128 v[226:229], v155 offset:2048
    ds_read_b128 v[230:233], v155 offset:3072
    ds_read_b32 v182, v156
    ds_read_b128 v[96:99], v157 offset:0
    ds_read_b128 v[100:103], v157 offset:1024
    ds_read_b128 v[104:107], v157 offset:2048
    ds_read_b128 v[108:111], v157 offset:3072
    s_waitcnt lgkmcnt(4)
    v_add_f32 v64, v64, v218
    v_add_f32 v65, v65, v219
    v_add_f32 v66, v66, v220
    v_add_f32 v67, v67, v221
    v_add_f32 v68, v68, v222
    v_add_f32 v69, v69, v223
    v_add_f32 v70, v70, v224
    v_add_f32 v71, v71, v225
    v_add_f32 v72, v72, v226
    v_add_f32 v73, v73, v227
    v_add_f32 v74, v74, v228
    v_add_f32 v75, v75, v229
    v_add_f32 v76, v76, v230
    v_add_f32 v77, v77, v231
    v_add_f32 v78, v78, v232
    v_add_f32 v79, v79, v233
    v_add_f32 v178, v178, v182
    v_cvt_pk_bf16_f32 v202, v64, v65
    v_cvt_pk_bf16_f32 v203, v66, v67
    v_cvt_pk_bf16_f32 v204, v68, v69
    v_cvt_pk_bf16_f32 v205, v70, v71
    v_cvt_pk_bf16_f32 v206, v72, v73
    v_cvt_pk_bf16_f32 v207, v74, v75
    v_cvt_pk_bf16_f32 v208, v76, v77
    v_cvt_pk_bf16_f32 v209, v78, v79
    s_lshl_b32 s65, s52, 4
    s_add_u32 s65, s65, s53
    s_lshl_b32 s65, s65, 2
    s_add_u32 s65, s65, s64
    s_lshl_b32 s65, s65, 11
    s_add_u32 s65, s65, 0x1000000
    buffer_store_dwordx4 v[202:205], v254, s[12:15], s65 offen sc1
    buffer_store_dwordx4 v[206:209], v254, s[12:15], s65 offen offset:1024 sc1
    s_lshl_b32 s65, s52, 2
    s_add_u32 s65, s65, s64
    s_lshl_b32 s65, s65, 4
    s_add_u32 s65, s65, s53
    s_lshl_b32 s65, s65, 7
    s_add_u32 s65, s65, 0x1200000
    v_lshlrev_b32 v155, 2, v253
    s_mov_b32 exec_hi, 0
    buffer_store_dword v178, v155, s[12:15], s65 offen sc1
    s_mov_b64 exec, -1
    s_waitcnt lgkmcnt(0)
    s_branch L_attn
L_epiB:
    s_setprio 1
    s_lshl_b32 s64, s55, 18
    s_lshl_b32 s65, s53, 14
    s_add_u32 s64, s64, s65
    s_lshl_b32 s65, s51, 13
    s_add_u32 s64, s64, s65
    v_add_u32 v155, s64, v254
    v_cvt_pk_bf16_f32 v112, v32, v33
    v_cvt_pk_bf16_f32 v113, v34, v35
    v_cvt_pk_bf16_f32 v114, v36, v37
    v_cvt_pk_bf16_f32 v115, v38, v39
    v_cvt_pk_bf16_f32 v116, v40, v41
    v_cvt_pk_bf16_f32 v117, v42, v43
    v_cvt_pk_bf16_f32 v118, v44, v45
    v_cvt_pk_bf16_f32 v119, v46, v47
    buffer_store_dwordx4 v[112:115], v155, s[12:15], 0 offen sc1
    buffer_store_dwordx4 v[116:119], v155, s[12:15], 0 offen offset:1024 sc1
    v_cvt_pk_bf16_f32 v120, v48, v49
    v_cvt_pk_bf16_f32 v121, v50, v51
    v_cvt_pk_bf16_f32 v122, v52, v53
    v_cvt_pk_bf16_f32 v123, v54, v55
    v_cvt_pk_bf16_f32 v124, v56, v57
    v_cvt_pk_bf16_f32 v125, v58, v59
    v_cvt_pk_bf16_f32 v126, v60, v61
    v_cvt_pk_bf16_f32 v127, v62, v63
    buffer_store_dwordx4 v[120:123], v155, s[12:15], s76 offen sc1
    buffer_store_dwordx4 v[124:127], v155, s[12:15], s76 offen offset:1024 sc1
    v_cvt_pk_bf16_f32 v128, v64, v65
    v_cvt_pk_bf16_f32 v129, v66, v67
    v_cvt_pk_bf16_f32 v130, v68, v69
    v_cvt_pk_bf16_f32 v131, v70, v71
    v_cvt_pk_bf16_f32 v132, v72, v73
    v_cvt_pk_bf16_f32 v133, v74, v75
    v_cvt_pk_bf16_f32 v134, v76, v77
    v_cvt_pk_bf16_f32 v135, v78, v79
    buffer_store_dwordx4 v[128:131], v155, s[12:15], 0 offen offset:2048 sc1
    buffer_store_dwordx4 v[132:135], v155, s[12:15], 0 offen offset:3072 sc1
    v_cvt_pk_bf16_f32 v136, v80, v81
    v_cvt_pk_bf16_f32 v137, v82, v83
    v_cvt_pk_bf16_f32 v138, v84, v85
    v_cvt_pk_bf16_f32 v139, v86, v87
    v_cvt_pk_bf16_f32 v140, v88, v89
    v_cvt_pk_bf16_f32 v141, v90, v91
    v_cvt_pk_bf16_f32 v142, v92, v93
    v_cvt_pk_bf16_f32 v143, v94, v95
    buffer_store_dwordx4 v[136:139], v155, s[12:15], s76 offen offset:2048 sc1
    buffer_store_dwordx4 v[140:143], v155, s[12:15], s76 offen offset:3072 sc1
    s_lshl_b32 s64, s50, 1
    s_add_u32 s64, s64, s51
    s_lshl_b32 s64, s64, 12
    s_add_u32 s64, s64, 75776
    v_add_u32 v156, s64, v254
    v_mul_f32 v16, s70, v16
    v_mul_f32 v17, s70, v17
    v_mul_f32 v18, s70, v18
    v_mul_f32 v19, s70, v19
    v_mul_f32 v20, s70, v20
    v_mul_f32 v21, s70, v21
    v_mul_f32 v22, s70, v22
    v_mul_f32 v23, s70, v23
    v_mul_f32 v24, s70, v24
    v_mul_f32 v25, s70, v25
    v_mul_f32 v26, s70, v26
    v_mul_f32 v27, s70, v27
    v_mul_f32 v28, s70, v28
    v_mul_f32 v29, s70, v29
    v_mul_f32 v30, s70, v30
    v_mul_f32 v31, s70, v31
    v_cvt_pk_bf16_f32 v96, v16, v17
    v_cvt_pk_bf16_f32 v97, v18, v19
    v_cvt_pk_bf16_f32 v98, v20, v21
    v_cvt_pk_bf16_f32 v99, v22, v23
    v_cvt_pk_bf16_f32 v100, v24, v25
    v_cvt_pk_bf16_f32 v101, v26, v27
    v_cvt_pk_bf16_f32 v102, v28, v29
    v_cvt_pk_bf16_f32 v103, v30, v31
    ds_write_b128 v156, v[96:99] offset:2048
    ds_write_b128 v156, v[100:103] offset:3072
    v_mul_f32 v0, s70, v0
    v_mul_f32 v1, s70, v1
    v_mul_f32 v2, s70, v2
    v_mul_f32 v3, s70, v3
    v_mul_f32 v4, s70, v4
    v_mul_f32 v5, s70, v5
    v_mul_f32 v6, s70, v6
    v_mul_f32 v7, s70, v7
    v_mul_f32 v8, s70, v8
    v_mul_f32 v9, s70, v9
    v_mul_f32 v10, s70, v10
    v_mul_f32 v11, s70, v11
    v_mul_f32 v12, s70, v12
    v_mul_f32 v13, s70, v13
    v_mul_f32 v14, s70, v14
    v_mul_f32 v15, s70, v15
    v_cvt_pk_bf16_f32 v104, v0, v1
    v_cvt_pk_bf16_f32 v105, v2, v3
    v_cvt_pk_bf16_f32 v106, v4, v5
    v_cvt_pk_bf16_f32 v107, v6, v7
    v_cvt_pk_bf16_f32 v108, v8, v9
    v_cvt_pk_bf16_f32 v109, v10, v11
    v_cvt_pk_bf16_f32 v110, v12, v13
    v_cvt_pk_bf16_f32 v111, v14, v15
    ds_write_b128 v156, v[104:107] offset:0
    ds_write_b128 v156, v[108:111] offset:1024
    v_bfe_u32 v155, v253, 2, 2
    v_lshlrev_b32 v155, 6, v155
    v_bfe_u32 v156, v253, 4, 1
    v_lshl_add_u32 v155, v156, 5, v155
    v_and_b32 v156, 3, v253
    v_lshl_add_u32 v155, v156, 3, v155
    v_lshl_add_u32 v155, v255, 8, v155
    s_lshl_b32 s64, s50, 11
    s_add_u32 s64, s64, 0x24000
    v_add_u32 v155, s64, v155
    ds_read_b64_tr_b16 v[144:145], v155 offset:0
    ds_read_b64_tr_b16 v[146:147], v155 offset:512
    ds_read_b64_tr_b16 v[148:149], v155 offset:1024
    ds_read_b64_tr_b16 v[150:151], v155 offset:1536
    s_lshl_b32 s64, s50, 1
    s_add_u32 s64, s64, s51
    s_lshl_b32 s65, s64, 13
    s_add_u32 s65, s65, 0x4000
    v_add_u32 v157, s65, v254
    s_lshl_b32 s64, s64, 2
    s_add_u32 s64, s64, 0x27880
    v_mov_b32 v158, s64
    s_mov_b32 s71, 0
L_lspin_29:
    ds_read_b32 v155, v158
    s_waitcnt lgkmcnt(0)
    v_cmp_ne_u32 vcc, 1, v155
    s_cbranch_vccz L_lok_30
    s_add_u32 s71, s71, 1
    s_cmp_ge_u32 s71, 0x10000
    s_cbranch_scc1 L_lok_30
    s_sleep 1
    s_branch L_lspin_29
L_lok_30:
    ds_read_b128 v[112:115], v157 offset:0
    ds_read_b128 v[116:119], v157 offset:1024
    ds_read_b128 v[120:123], v157 offset:2048
    ds_read_b128 v[124:127], v157 offset:3072
    s_mul_i32 s66, s51, 0x80008000
    v_xor_b32 v144, s66, v144
    v_xor_b32 v145, s66, v145
    v_xor_b32 v146, s66, v146
    v_xor_b32 v147, s66, v147
    v_xor_b32 v148, s66, v148
    v_xor_b32 v149, s66, v149
    v_xor_b32 v150, s66, v150
    v_xor_b32 v151, s66, v151
    s_lshl_b32 s64, s50, 1
    s_add_u32 s64, s64, s51
    s_lshl_b32 s64, s64, 13
    s_add_u32 s64, s64, 0x4000
    s_lshl_b32 s65, s51, 11
    s_add_u32 s65, s65, s64
    v_add_u32 v157, s65, v254
    v_xor_b32 v158, 2048, v157
    s_waitcnt lgkmcnt(0)
    v_mfma_f32_32x32x16_bf16 v[0:15], v[144:147], v[112:115], 0
    v_mfma_f32_32x32x16_bf16 v[0:15], v[148:151], v[116:119], v[0:15]
    v_mfma_f32_32x32x16_bf16 v[16:31], v[144:147], v[120:123], 0
    v_mfma_f32_32x32x16_bf16 v[16:31], v[148:151], v[124:127], v[16:31]
    s_nop 9
    v_max3_f32 v160, v0, v1, v2
    v_max3_f32 v161, -v0, -v1, -v2
    v_max3_f32 v160, v160, v3, v4
    v_max3_f32 v161, v161, -v3, -v4
    v_max3_f32 v160, v160, v5, v6
    v_max3_f32 v161, v161, -v5, -v6
    v_max3_f32 v160, v160, v7, v8
    v_max3_f32 v161, v161, -v7, -v8
    v_max3_f32 v160, v160, v9, v10
    v_max3_f32 v161, v161, -v9, -v10
    v_max3_f32 v160, v160, v11, v12
    v_max3_f32 v161, v161, -v11, -v12
    v_max3_f32 v160, v160, v13, v14
    v_max3_f32 v161, v161, -v13, -v14
    v_max_f32 v160, v160, v15
    v_max_f32_e64 v161, v161, -v15
    s_nop 1
    v_permlane32_swap_b32 v160, v161
    v_max_f32 v160, v160, v161
    v_mov_b32 v161, v160
    s_nop 1
    v_permlane32_swap_b32 v160, v161
    v_mul_f32 v160, s69, v160
    v_mul_f32 v161, s69, v161
    v_fma_f32 v186, v0, s69, -v160
    v_fma_f32 v0, v0, -s69, -v161
    v_fma_f32 v187, v1, s69, -v160
    v_fma_f32 v1, v1, -s69, -v161
    v_fma_f32 v188, v2, s69, -v160
    v_fma_f32 v2, v2, -s69, -v161
    v_fma_f32 v189, v3, s69, -v160
    v_fma_f32 v3, v3, -s69, -v161
    v_fma_f32 v190, v4, s69, -v160
    v_fma_f32 v4, v4, -s69, -v161
    v_fma_f32 v191, v5, s69, -v160
    v_fma_f32 v5, v5, -s69, -v161
    v_fma_f32 v192, v6, s69, -v160
    v_fma_f32 v6, v6, -s69, -v161
    v_fma_f32 v193, v7, s69, -v160
    v_fma_f32 v7, v7, -s69, -v161
    v_fma_f32 v194, v8, s69, -v160
    v_fma_f32 v8, v8, -s69, -v161
    v_fma_f32 v195, v9, s69, -v160
    v_fma_f32 v9, v9, -s69, -v161
    v_fma_f32 v196, v10, s69, -v160
    v_fma_f32 v10, v10, -s69, -v161
    v_fma_f32 v197, v11, s69, -v160
    v_fma_f32 v11, v11, -s69, -v161
    v_fma_f32 v198, v12, s69, -v160
    v_fma_f32 v12, v12, -s69, -v161
    v_fma_f32 v199, v13, s69, -v160
    v_fma_f32 v13, v13, -s69, -v161
    v_fma_f32 v200, v14, s69, -v160
    v_fma_f32 v14, v14, -s69, -v161
    v_fma_f32 v201, v15, s69, -v160
    v_fma_f32 v15, v15, -s69, -v161
    v_exp_f32 v186, v186
    v_exp_f32 v0, v0
    v_exp_f32 v187, v187
    v_exp_f32 v1, v1
    v_exp_f32 v188, v188
    v_exp_f32 v2, v2
    v_exp_f32 v189, v189
    v_exp_f32 v3, v3
    v_exp_f32 v190, v190
    v_exp_f32 v4, v4
    v_exp_f32 v191, v191
    v_exp_f32 v5, v5
    v_exp_f32 v192, v192
    v_exp_f32 v6, v6
    v_exp_f32 v193, v193
    v_exp_f32 v7, v7
    v_exp_f32 v194, v194
    v_exp_f32 v8, v8
    v_exp_f32 v195, v195
    v_exp_f32 v9, v9
    v_exp_f32 v196, v196
    v_exp_f32 v10, v10
    v_exp_f32 v197, v197
    v_exp_f32 v11, v11
    v_exp_f32 v198, v198
    v_exp_f32 v12, v12
    v_exp_f32 v199, v199
    v_exp_f32 v13, v13
    v_exp_f32 v200, v200
    v_exp_f32 v14, v14
    v_exp_f32 v201, v201
    v_exp_f32 v15, v15
    v_add_f32 v162, v186, v187
    v_add_f32 v163, v0, v1
    v_add_f32 v162, v162, v188
    v_add_f32 v163, v163, v2
    v_add_f32 v162, v162, v189
    v_add_f32 v163, v163, v3
    v_add_f32 v162, v162, v190
    v_add_f32 v163, v163, v4
    v_add_f32 v162, v162, v191
    v_add_f32 v163, v163, v5
    v_add_f32 v162, v162, v192
    v_add_f32 v163, v163, v6
    v_add_f32 v162, v162, v193
    v_add_f32 v163, v163, v7
    v_add_f32 v162, v162, v194
    v_add_f32 v163, v163, v8
    v_add_f32 v162, v162, v195
    v_add_f32 v163, v163, v9
    v_add_f32 v162, v162, v196
    v_add_f32 v163, v163, v10
    v_add_f32 v162, v162, v197
    v_add_f32 v163, v163, v11
    v_add_f32 v162, v162, v198
    v_add_f32 v163, v163, v12
    v_add_f32 v162, v162, v199
    v_add_f32 v163, v163, v13
    v_add_f32 v162, v162, v200
    v_add_f32 v163, v163, v14
    v_add_f32 v162, v162, v201
    v_add_f32 v163, v163, v15
    s_nop 1
    v_permlane32_swap_b32 v162, v163
    v_add_f32 v162, v162, v163
    v_mov_b32 v163, v162
    s_nop 1
    v_permlane32_swap_b32 v162, v163
    v_rcp_f32 v162, v162
    v_rcp_f32 v163, v163
    v_mul_f32 v186, v186, v162
    v_mul_f32 v0, v0, v163
    v_mul_f32 v187, v187, v162
    v_mul_f32 v1, v1, v163
    v_mul_f32 v188, v188, v162
    v_mul_f32 v2, v2, v163
    v_mul_f32 v189, v189, v162
    v_mul_f32 v3, v3, v163
    v_mul_f32 v190, v190, v162
    v_mul_f32 v4, v4, v163
    v_mul_f32 v191, v191, v162
    v_mul_f32 v5, v5, v163
    v_mul_f32 v192, v192, v162
    v_mul_f32 v6, v6, v163
    v_mul_f32 v193, v193, v162
    v_mul_f32 v7, v7, v163
    v_mul_f32 v194, v194, v162
    v_mul_f32 v8, v8, v163
    v_mul_f32 v195, v195, v162
    v_mul_f32 v9, v9, v163
    v_mul_f32 v196, v196, v162
    v_mul_f32 v10, v10, v163
    v_mul_f32 v197, v197, v162
    v_mul_f32 v11, v11, v163
    v_mul_f32 v198, v198, v162
    v_mul_f32 v12, v12, v163
    v_mul_f32 v199, v199, v162
    v_mul_f32 v13, v13, v163
    v_mul_f32 v200, v200, v162
    v_mul_f32 v14, v14, v163
    v_mul_f32 v201, v201, v162
    v_mul_f32 v15, v15, v163
    v_cvt_pk_bf16_f32 v202, v186, v187
    v_cvt_pk_bf16_f32 v210, v0, v1
    v_cvt_pk_bf16_f32 v203, v188, v189
    v_cvt_pk_bf16_f32 v211, v2, v3
    v_cvt_pk_bf16_f32 v204, v190, v191
    v_cvt_pk_bf16_f32 v212, v4, v5
    v_cvt_pk_bf16_f32 v205, v192, v193
    v_cvt_pk_bf16_f32 v213, v6, v7
    v_cvt_pk_bf16_f32 v206, v194, v195
    v_cvt_pk_bf16_f32 v214, v8, v9
    v_cvt_pk_bf16_f32 v207, v196, v197
    v_cvt_pk_bf16_f32 v215, v10, v11
    v_cvt_pk_bf16_f32 v208, v198, v199
    v_cvt_pk_bf16_f32 v216, v12, v13
    v_cvt_pk_bf16_f32 v209, v200, v201
    v_cvt_pk_bf16_f32 v217, v14, v15
    ds_write_b128 v157, v[202:205] offset:0
    ds_write_b128 v158, v[210:213] offset:0
    ds_write_b128 v157, v[206:209] offset:1024
    ds_write_b128 v158, v[214:217] offset:1024
    s_setprio 0
    s_waitcnt vmcnt(0)
    s_cmp_lg_u32 s48, 4
    s_cbranch_scc1 L_dbgok_31
    v_cmp_ne_u32 vcc, 1, v165
    s_cbranch_vccz L_dbgok_31
    v_mov_b32 v166, 0
    s_mov_b32 s71, 0
    s_mov_b32 s68, 0x0
L_poll_32:
    buffer_load_dword v165, v166, s[20:23], s68 offen sc1
    s_waitcnt vmcnt(0)
    v_cmp_ne_u32 vcc, 1, v165
    s_cbranch_vccz L_polled_33
    s_add_u32 s71, s71, 1
    s_cmp_ge_u32 s71, 0x10000
    s_cbranch_scc1 L_polled_33
    s_sleep 1
    s_branch L_poll_32
L_polled_33:
L_dbgok_31:
    s_mov_b64 exec, 1
    v_mov_b32 v166, 0x27a00
    v_mov_b32 v167, 1
    ds_add_rtn_u32 v167, v166, v167
    s_waitcnt lgkmcnt(0)
    v_cmp_ne_u32 vcc, 3, v167
    s_cbranch_vccnz L_noflag_34
    s_lshl_b32 s64, s52, 7
    s_lshl_b32 s65, s53, 2
    s_add_u32 s64, s64, s65
    s_add_u32 s64, s64, 0x1300000
    v_mov_b32 v167, 1
    v_mov_b32 v166, 0
    buffer_store_dword v167, v166, s[12:15], s64 offen sc1
L_noflag_34:
    s_mov_b64 exec, -1
    v_max3_f32 v160, v16, v17, v18
    v_max3_f32 v161, -v16, -v17, -v18
    v_max3_f32 v160, v160, v19, v20
    v_max3_f32 v161, v161, -v19, -v20
    v_max3_f32 v160, v160, v21, v22
    v_max3_f32 v161, v161, -v21, -v22
    v_max3_f32 v160, v160, v23, v24
    v_max3_f32 v161, v161, -v23, -v24
    v_max3_f32 v160, v160, v25, v26
    v_max3_f32 v161, v161, -v25, -v26
    v_max3_f32 v160, v160, v27, v28
    v_max3_f32 v161, v161, -v27, -v28
    v_max3_f32 v160, v160, v29, v30
    v_max3_f32 v161, v161, -v29, -v30
    v_max_f32 v160, v160, v31
    v_max_f32_e64 v161, v161, -v31
    s_nop 1
    v_permlane32_swap_b32 v160, v161
    v_max_f32 v160, v160, v161
    v_mov_b32 v161, v160
    s_nop 1
    v_permlane32_swap_b32 v160, v161
    v_mul_f32 v160, s69, v160
    v_mul_f32 v161, s69, v161
    v_fma_f32 v186, v16, s69, -v160
    v_fma_f32 v16, v16, -s69, -v161
    v_fma_f32 v187, v17, s69, -v160
    v_fma_f32 v17, v17, -s69, -v161
    v_fma_f32 v188, v18, s69, -v160
    v_fma_f32 v18, v18, -s69, -v161
    v_fma_f32 v189, v19, s69, -v160
    v_fma_f32 v19, v19, -s69, -v161
    v_fma_f32 v190, v20, s69, -v160
    v_fma_f32 v20, v20, -s69, -v161
    v_fma_f32 v191, v21, s69, -v160
    v_fma_f32 v21, v21, -s69, -v161
    v_fma_f32 v192, v22, s69, -v160
    v_fma_f32 v22, v22, -s69, -v161
    v_fma_f32 v193, v23, s69, -v160
    v_fma_f32 v23, v23, -s69, -v161
    v_fma_f32 v194, v24, s69, -v160
    v_fma_f32 v24, v24, -s69, -v161
    v_fma_f32 v195, v25, s69, -v160
    v_fma_f32 v25, v25, -s69, -v161
    v_fma_f32 v196, v26, s69, -v160
    v_fma_f32 v26, v26, -s69, -v161
    v_fma_f32 v197, v27, s69, -v160
    v_fma_f32 v27, v27, -s69, -v161
    v_fma_f32 v198, v28, s69, -v160
    v_fma_f32 v28, v28, -s69, -v161
    v_fma_f32 v199, v29, s69, -v160
    v_fma_f32 v29, v29, -s69, -v161
    v_fma_f32 v200, v30, s69, -v160
    v_fma_f32 v30, v30, -s69, -v161
    v_fma_f32 v201, v31, s69, -v160
    v_fma_f32 v31, v31, -s69, -v161
    v_exp_f32 v186, v186
    v_exp_f32 v16, v16
    v_exp_f32 v187, v187
    v_exp_f32 v17, v17
    v_exp_f32 v188, v188
    v_exp_f32 v18, v18
    v_exp_f32 v189, v189
    v_exp_f32 v19, v19
    v_exp_f32 v190, v190
    v_exp_f32 v20, v20
    v_exp_f32 v191, v191
    v_exp_f32 v21, v21
    v_exp_f32 v192, v192
    v_exp_f32 v22, v22
    v_exp_f32 v193, v193
    v_exp_f32 v23, v23
    v_exp_f32 v194, v194
    v_exp_f32 v24, v24
    v_exp_f32 v195, v195
    v_exp_f32 v25, v25
    v_exp_f32 v196, v196
    v_exp_f32 v26, v26
    v_exp_f32 v197, v197
    v_exp_f32 v27, v27
    v_exp_f32 v198, v198
    v_exp_f32 v28, v28
    v_exp_f32 v199, v199
    v_exp_f32 v29, v29
    v_exp_f32 v200, v200
    v_exp_f32 v30, v30
    v_exp_f32 v201, v201
    v_exp_f32 v31, v31
    v_add_f32 v162, v186, v187
    v_add_f32 v163, v16, v17
    v_add_f32 v162, v162, v188
    v_add_f32 v163, v163, v18
    v_add_f32 v162, v162, v189
    v_add_f32 v163, v163, v19
    v_add_f32 v162, v162, v190
    v_add_f32 v163, v163, v20
    v_add_f32 v162, v162, v191
    v_add_f32 v163, v163, v21
    v_add_f32 v162, v162, v192
    v_add_f32 v163, v163, v22
    v_add_f32 v162, v162, v193
    v_add_f32 v163, v163, v23
    v_add_f32 v162, v162, v194
    v_add_f32 v163, v163, v24
    v_add_f32 v162, v162, v195
    v_add_f32 v163, v163, v25
    v_add_f32 v162, v162, v196
    v_add_f32 v163, v163, v26
    v_add_f32 v162, v162, v197
    v_add_f32 v163, v163, v27
    v_add_f32 v162, v162, v198
    v_add_f32 v163, v163, v28
    v_add_f32 v162, v162, v199
    v_add_f32 v163, v163, v29
    v_add_f32 v162, v162, v200
    v_add_f32 v163, v163, v30
    v_add_f32 v162, v162, v201
    v_add_f32 v163, v163, v31
    s_nop 1
    v_permlane32_swap_b32 v162, v163
    v_add_f32 v162, v162, v163
    v_mov_b32 v163, v162
    s_nop 1
    v_permlane32_swap_b32 v162, v163
    v_rcp_f32 v162, v162
    v_rcp_f32 v163, v163
    v_mul_f32 v186, v186, v162
    v_mul_f32 v16, v16, v163
    v_mul_f32 v187, v187, v162
    v_mul_f32 v17, v17, v163
    v_mul_f32 v188, v188, v162
    v_mul_f32 v18, v18, v163
    v_mul_f32 v189, v189, v162
    v_mul_f32 v19, v19, v163
    v_mul_f32 v190, v190, v162
    v_mul_f32 v20, v20, v163
    v_mul_f32 v191, v191, v162
    v_mul_f32 v21, v21, v163
    v_mul_f32 v192, v192, v162
    v_mul_f32 v22, v22, v163
    v_mul_f32 v193, v193, v162
    v_mul_f32 v23, v23, v163
    v_mul_f32 v194, v194, v162
    v_mul_f32 v24, v24, v163
    v_mul_f32 v195, v195, v162
    v_mul_f32 v25, v25, v163
    v_mul_f32 v196, v196, v162
    v_mul_f32 v26, v26, v163
    v_mul_f32 v197, v197, v162
    v_mul_f32 v27, v27, v163
    v_mul_f32 v198, v198, v162
    v_mul_f32 v28, v28, v163
    v_mul_f32 v199, v199, v162
    v_mul_f32 v29, v29, v163
    v_mul_f32 v200, v200, v162
    v_mul_f32 v30, v30, v163
    v_mul_f32 v201, v201, v162
    v_mul_f32 v31, v31, v163
    v_cvt_pk_bf16_f32 v202, v186, v187
    v_cvt_pk_bf16_f32 v210, v16, v17
    v_cvt_pk_bf16_f32 v203, v188, v189
    v_cvt_pk_bf16_f32 v211, v18, v19
    v_cvt_pk_bf16_f32 v204, v190, v191
    v_cvt_pk_bf16_f32 v212, v20, v21
    v_cvt_pk_bf16_f32 v205, v192, v193
    v_cvt_pk_bf16_f32 v213, v22, v23
    v_cvt_pk_bf16_f32 v206, v194, v195
    v_cvt_pk_bf16_f32 v214, v24, v25
    v_cvt_pk_bf16_f32 v207, v196, v197
    v_cvt_pk_bf16_f32 v215, v26, v27
    v_cvt_pk_bf16_f32 v208, v198, v199
    v_cvt_pk_bf16_f32 v216, v28, v29
    v_cvt_pk_bf16_f32 v209, v200, v201
    v_cvt_pk_bf16_f32 v217, v30, v31
    ds_write_b128 v157, v[202:205] offset:4096
    ds_write_b128 v158, v[210:213] offset:4096
    ds_write_b128 v157, v[206:209] offset:5120
    ds_write_b128 v158, v[214:217] offset:5120
    s_waitcnt lgkmcnt(0)
    s_barrier
    s_branch L_attn
L_attn:
    v_and_b32 v207, 4, v253
    v_mov_b32 v208, 0x3f803f80
    v_cmp_eq_u32 vcc, 0, v207
    s_nop 1
    v_cndmask_b32 v136, 0, v208, vcc
    v_sub_u32 v138, v208, v136
    v_cndmask_b32 v137, 0, v208, vcc
    v_sub_u32 v139, v208, v137
    v_and_b32 v207, 31, v253
    v_lshlrev_b32 v208, 2, v255
    v_sub_u32 v207, v207, v208
    s_lshl_b32 s64, s51, 4
    v_subrev_u32 v207, s64, v207
    v_and_b32 v208, 1, v207
    v_lshlrev_b32 v208, 4, v208
    v_mov_b32 v209, 0x3f80
    v_lshlrev_b32 v208, v208, v209
    v_ashrrev_i32 v207, 1, v207
    v_cmp_eq_u32 vcc, 0, v207
    s_nop 1
    v_cndmask_b32 v248, 0, v208, vcc
    v_cmp_eq_u32 vcc, 1, v207
    s_nop 1
    v_cndmask_b32 v249, 0, v208, vcc
    v_cmp_eq_u32 vcc, 4, v207
    s_nop 1
    v_cndmask_b32 v250, 0, v208, vcc
    v_cmp_eq_u32 vcc, 5, v207
    s_nop 1
    v_cndmask_b32 v251, 0, v208, vcc
    s_lshl_b32 s64, s55, 18
    s_lshl_b32 s65, s49, 17
    s_add_u32 s64, s64, s65
    v_add_u32 v204, s64, v254
    s_lshl_b32 s74, s53, 1
    s_lshl_b32 s77, s53, 13
    s_lshl_b32 s64, s52, 6
    s_lshl_b32 s65, s50, 1
    s_add_u32 s65, s65, s49
    s_add_u32 s64, s64, s65
    s_lshl_b32 s64, s64, 11
    s_lshl_b32 s66, s51, 10
    s_add_u32 s64, s64, s66
    s_add_u32 s80, s64, 0x1000000
    s_lshl_b32 s64, s52, 2
    s_add_u32 s64, s64, s65
    s_lshl_b32 s64, s64, 11
    s_add_u32 s73, s64, 0x1200000
    s_lshl_b32 s66, s53, 7
    s_lshl_b32 s67, s52, 2
    s_add_u32 s83, s66, s67
    s_add_u32 s84, s83, 0x1318000
    s_add_u32 s83, s83, 0x1310000
    s_and_b32 s64, s2, 7
    s_lshr_b32 s65, s2, 3
    s_and_b32 s66, s64, 3
    s_lshl_b32 s66, s66, 2
    s_and_b32 s67, s65, 3
    s_add_u32 s81, s66, s67
    s_lshr_b32 s66, s64, 2
    s_lshl_b32 s66, s66, 3
    s_lshr_b32 s67, s65, 2
    s_add_u32 s82, s66, s67
    s_and_b32 s85, s82, 7
    s_mov_b32 s8, s34
    s_mov_b32 s9, s35
    s_mov_b32 s10, 0x200000
    s_mov_b32 s11, 0x20000
    s_mov_b32 s24, s38
    s_mov_b32 s25, s39
    s_mov_b32 s26, 0x200000
    s_mov_b32 s27, 0x20000
    s_and_b32 s64, s48, 3
    s_lshl_b32 s56, s49, 13
    s_lshl_b32 s64, s64, 11
    s_add_u32 s56, s56, s64
    v_and_b32 v207, 15, v253
    v_lshlrev_b32 v207, 2, v207
    s_lshl_b32 s64, s52, 7
    v_add_u32 v207, s64, v207
    v_and_b32 v205, 1, v253
    v_mul_u32_u24 v205, 0xaaaa, v205
    v_add_u32 v205, 0x4444, v205
    v_mov_b32 v128, 0
    v_mov_b32 v132, 0
    v_mov_b32 v129, 0
    v_mov_b32 v133, 0
    v_mov_b32 v130, 0
    v_mov_b32 v134, 0
    v_mov_b32 v131, 0
    v_mov_b32 v135, 0
    s_mov_b32 s71, 0
    s_mov_b32 s68, 0x1300000
L_poll_35:
    buffer_load_dword v208, v207, s[12:15], s68 offen sc1
    s_waitcnt vmcnt(0)
    v_cmp_ne_u32 vcc, 1, v208
    s_cbranch_vccz L_polled_36
    s_add_u32 s71, s71, 1
    s_cmp_ge_u32 s71, 0x10000
    s_cbranch_scc1 L_polled_36
    s_sleep 1
    s_branch L_poll_35
L_polled_36:
    buffer_load_dwordx4 v[140:143], v204, s[12:15], s77 offen
    buffer_load_dwordx4 v[144:147], v204, s[12:15], s77 offen offset:1024
    s_cmp_eq_u32 s49, 0
    s_cbranch_scc0 L_noF1b_37
    s_mov_b64 exec, 1
    v_mov_b32 v207, 0x27a04
    v_mov_b32 v208, 1
    ds_add_rtn_u32 v208, v207, v208
    s_waitcnt lgkmcnt(0)
    v_cmp_ne_u32 vcc, 3, v208
    s_cbranch_vccnz L_noflag_38
    s_lshl_b32 s64, s52, 7
    s_lshl_b32 s65, s53, 2
    s_add_u32 s64, s64, s65
    s_add_u32 s64, s64, 0x1308000
    v_mov_b32 v208, 1
    v_mov_b32 v207, 0
    buffer_store_dword v208, v207, s[12:15], s64 offen sc1
L_noflag_38:
    s_mov_b64 exec, -1
L_noF1b_37:
    buffer_load_dwordx4 v[148:151], v204, s[12:15], s77 offen offset:2048
    buffer_load_dwordx4 v[152:155], v204, s[12:15], s77 offen offset:3072
    s_add_u32 s77, s77, 4096
    s_and_b32 s77, s77, 0x1ffff
    s_waitcnt vmcnt(2)
    v_mfma_f32_32x32x16_bf16 v[0:15], v[140:143], v[96:99], 0
    buffer_load_dwordx4 v[156:159], v204, s[12:15], s77 offen
    v_mfma_f32_32x32x16_bf16 v[16:31], v[140:143], v[104:107], 0
    buffer_load_dwordx4 v[160:163], v204, s[12:15], s77 offen offset:1024
    v_mfma_f32_32x32x16_bf16 v[0:15], v[144:147], v[100:103], v[0:15]
    buffer_load_dwordx4 v[164:167], v204, s[12:15], s77 offen offset:2048
    v_mfma_f32_32x32x16_bf16 v[16:31], v[144:147], v[108:111], v[16:31]
    buffer_load_dwordx4 v[168:171], v204, s[12:15], s77 offen offset:3072
    s_add_u32 s77, s77, 4096
    s_and_b32 s77, s77, 0x1ffff
    s_nop 6
    v_max3_f32 v209, v0, v1, v2
    v_max3_f32 v209, v209, v3, v4
    v_max3_f32 v209, v209, v5, v6
    v_max3_f32 v209, v209, v7, v8
    v_max3_f32 v209, v209, v9, v10
    v_max3_f32 v209, v209, v11, v12
    v_max3_f32 v209, v209, v13, v14
    v_max_f32 v209, v209, v15
    v_max3_f32 v210, v16, v17, v18
    v_max3_f32 v210, v210, v19, v20
    v_max3_f32 v210, v210, v21, v22
    v_max3_f32 v210, v210, v23, v24
    v_max3_f32 v210, v210, v25, v26
    v_max3_f32 v210, v210, v27, v28
    v_max3_f32 v210, v210, v29, v30
    v_max_f32 v210, v210, v31
    v_mov_b32 v207, v209
    s_nop 1
    v_permlane32_swap_b32 v209, v207
    v_max_f32 v209, v209, v207
    v_mov_b32 v207, v210
    s_nop 1
    v_permlane32_swap_b32 v210, v207
    v_max_f32 v210, v210, v207
    v_add_f32 v209, 0x42c80000, v209
    v_add_f32 v210, 0x42c80000, v210
    v_sub_f32 v32, 0, v209
    v_sub_f32 v33, 0, v209
    v_sub_f32 v34, 0, v209
    v_sub_f32 v35, 0, v209
    v_sub_f32 v36, 0, v209
    v_sub_f32 v37, 0, v209
    v_sub_f32 v38, 0, v209
    v_sub_f32 v39, 0, v209
    v_sub_f32 v40, 0, v209
    v_sub_f32 v41, 0, v209
    v_sub_f32 v42, 0, v209
    v_sub_f32 v43, 0, v209
    v_sub_f32 v44, 0, v209
    v_sub_f32 v45, 0, v209
    v_sub_f32 v46, 0, v209
    v_sub_f32 v47, 0, v209
    s_nop 1
    v_mfma_f32_32x32x16_bf16 v[0:15], v[140:143], v[96:99], v[32:47]
    buffer_load_dwordx4 v[172:175], v204, s[12:15], s77 offen
    v_mfma_f32_32x32x16_bf16 v[0:15], v[144:147], v[100:103], v[0:15]
    buffer_load_dwordx4 v[176:179], v204, s[12:15], s77 offen offset:1024
    v_sub_f32 v48, 0, v210
    v_sub_f32 v49, 0, v210
    buffer_load_dwordx4 v[180:183], v204, s[12:15], s77 offen offset:2048
    v_sub_f32 v50, 0, v210
    v_sub_f32 v51, 0, v210
    v_sub_f32 v52, 0, v210
    v_sub_f32 v53, 0, v210
    v_sub_f32 v54, 0, v210
    v_sub_f32 v55, 0, v210
    v_sub_f32 v56, 0, v210
    buffer_load_dwordx4 v[184:187], v204, s[12:15], s77 offen offset:3072
    s_add_u32 s77, s77, 4096
    s_and_b32 s77, s77, 0x1ffff
    v_sub_f32 v57, 0, v210
    v_sub_f32 v58, 0, v210
    v_sub_f32 v59, 0, v210
    v_sub_f32 v60, 0, v210
    v_sub_f32 v61, 0, v210
    v_sub_f32 v62, 0, v210
    v_sub_f32 v63, 0, v210
    s_setprio 1
    s_cmp_eq_u32 s49, 0
    s_cbranch_scc0 L_pr_39
    s_setprio 2
L_pr_39:
    v_mfma_f32_32x32x16_bf16 v[16:31], v[140:143], v[104:107], v[48:63]
    v_exp_f32 v0, v0
    v_exp_f32 v1, v1
    v_exp_f32 v2, v2
    v_exp_f32 v3, v3
    v_cvt_pk_bf16_f32 v112, v0, v1
    v_cvt_pk_bf16_f32 v113, v2, v3
    v_exp_f32 v4, v4
    v_exp_f32 v5, v5
    v_exp_f32 v6, v6
    v_exp_f32 v7, v7
    v_cvt_pk_bf16_f32 v114, v4, v5
    v_cvt_pk_bf16_f32 v115, v6, v7
    v_mfma_f32_32x32x16_bf16 v[16:31], v[144:147], v[108:111], v[16:31]
    buffer_load_dwordx4 v[188:191], v204, s[12:15], s77 offen
    buffer_load_dwordx4 v[192:195], v204, s[12:15], s77 offen offset:1024
    v_exp_f32 v8, v8
    v_exp_f32 v9, v9
    v_exp_f32 v10, v10
    v_exp_f32 v11, v11
    v_cvt_pk_bf16_f32 v116, v8, v9
    v_cvt_pk_bf16_f32 v117, v10, v11
    v_exp_f32 v12, v12
    v_exp_f32 v13, v13
    v_exp_f32 v14, v14
    v_exp_f32 v15, v15
    v_cvt_pk_bf16_f32 v118, v12, v13
    v_cvt_pk_bf16_f32 v119, v14, v15
    s_waitcnt vmcnt(8)
    v_mfma_f32_32x32x16_bf16 v[0:15], v[156:159], v[96:99], v[32:47]
    s_and_b32 s64, s2, 7
    s_lshr_b32 s65, s2, 3
    s_lshr_b32 s66, s64, 2
    s_lshl_b32 s66, s66, 3
    s_lshr_b32 s67, s65, 2
    s_add_u32 s66, s66, s67
    s_lshl_b32 s66, s66, 7
    s_and_b32 s65, s65, 3
    s_lshl_b32 s65, s65, 3
    s_add_u32 s65, s65, s48
    s_lshl_b32 s65, s65, 16
    s_add_u32 s66, s66, s65
    s_add_u32 s88, s34, s66
    s_addc_u32 s89, s35, 0
    v_exp_f32 v16, v16
    v_exp_f32 v17, v17
    v_exp_f32 v18, v18
    v_exp_f32 v19, v19
    v_mfma_f32_32x32x16_bf16 v[0:15], v[160:163], v[100:103], v[0:15]
    v_cvt_pk_bf16_f32 v120, v16, v17
    v_cvt_pk_bf16_f32 v121, v18, v19
    v_exp_f32 v20, v20
    v_exp_f32 v21, v21
    v_exp_f32 v22, v22
    v_mfma_f32_32x32x16_bf16 v[64:79], v[148:151], v[112:115], 0
    buffer_load_dwordx4 v[196:199], v204, s[12:15], s77 offen offset:2048
    v_exp_f32 v23, v23
    v_cvt_pk_bf16_f32 v122, v20, v21
    v_cvt_pk_bf16_f32 v123, v22, v23
    v_exp_f32 v24, v24
    v_exp_f32 v25, v25
    v_mfma_f32_32x32x16_bf16 v[64:79], v[152:155], v[116:119], v[64:79]
    buffer_load_dwordx4 v[200:203], v204, s[12:15], s77 offen offset:3072
    s_add_u32 s77, s77, 4096
    s_and_b32 s77, s77, 0x1ffff
    v_exp_f32 v26, v26
    v_exp_f32 v27, v27
    v_cvt_pk_bf16_f32 v124, v24, v25
    v_cvt_pk_bf16_f32 v125, v26, v27
    v_exp_f32 v28, v28
    v_smfmac_f32_16x16x64_bf16 v[128:131], v[136:139], v[112:119], v205
    v_exp_f32 v29, v29
    v_exp_f32 v30, v30
    v_exp_f32 v31, v31
    v_cvt_pk_bf16_f32 v126, v28, v29
    v_cvt_pk_bf16_f32 v127, v30, v31
    s_cmp_eq_u32 s49, 0
    s_cbranch_scc0 L_pr_40
    s_setprio 0
L_pr_40:
    v_mfma_f32_32x32x16_bf16 v[16:31], v[156:159], v[104:107], v[48:63]
    v_exp_f32 v0, v0
    v_exp_f32 v1, v1
    v_exp_f32 v2, v2
    v_exp_f32 v3, v3
    v_mfma_f32_32x32x16_bf16 v[16:31], v[160:163], v[108:111], v[16:31]
    buffer_load_dwordx4 v[140:143], v204, s[12:15], s77 offen
    v_cvt_pk_bf16_f32 v112, v0, v1
    v_cvt_pk_bf16_f32 v113, v2, v3
    v_exp_f32 v4, v4
    v_exp_f32 v5, v5
    v_exp_f32 v6, v6
    v_mfma_f32_32x32x16_bf16 v[80:95], v[148:151], v[120:123], 0
    v_exp_f32 v7, v7
    v_cvt_pk_bf16_f32 v114, v4, v5
    v_cvt_pk_bf16_f32 v115, v6, v7
    v_exp_f32 v8, v8
    v_exp_f32 v9, v9
    v_mfma_f32_32x32x16_bf16 v[80:95], v[152:155], v[124:127], v[80:95]
    buffer_load_dwordx4 v[144:147], v204, s[12:15], s77 offen offset:1024
    v_exp_f32 v10, v10
    v_exp_f32 v11, v11
    v_cvt_pk_bf16_f32 v116, v8, v9
    v_cvt_pk_bf16_f32 v117, v10, v11
    v_exp_f32 v12, v12
    v_smfmac_f32_16x16x64_bf16 v[132:135], v[136:139], v[120:127], v205
    v_exp_f32 v13, v13
    v_exp_f32 v14, v14
    v_exp_f32 v15, v15
    v_cvt_pk_bf16_f32 v118, v12, v13
    v_cvt_pk_bf16_f32 v119, v14, v15
    s_waitcnt vmcnt(8)
    v_mfma_f32_32x32x16_bf16 v[0:15], v[172:175], v[96:99], v[32:47]
    v_exp_f32 v16, v16
    v_exp_f32 v17, v17
    v_exp_f32 v18, v18
    v_exp_f32 v19, v19
    v_mfma_f32_32x32x16_bf16 v[0:15], v[176:179], v[100:103], v[0:15]
    buffer_load_dwordx4 v[148:151], v204, s[12:15], s77 offen offset:2048
    v_cvt_pk_bf16_f32 v120, v16, v17
    v_cvt_pk_bf16_f32 v121, v18, v19
    v_exp_f32 v20, v20
    v_exp_f32 v21, v21
    v_exp_f32 v22, v22
    v_mfma_f32_32x32x16_bf16 v[64:79], v[164:167], v[112:115], v[64:79]
    v_exp_f32 v23, v23
    v_cvt_pk_bf16_f32 v122, v20, v21
    v_cvt_pk_bf16_f32 v123, v22, v23
    v_exp_f32 v24, v24
    v_exp_f32 v25, v25
    v_mfma_f32_32x32x16_bf16 v[64:79], v[168:171], v[116:119], v[64:79]
    buffer_load_dwordx4 v[152:155], v204, s[12:15], s77 offen offset:3072
    s_add_u32 s77, s77, 4096
    s_and_b32 s77, s77, 0x1ffff
    v_exp_f32 v26, v26
    v_exp_f32 v27, v27
    v_cvt_pk_bf16_f32 v124, v24, v25
    v_cvt_pk_bf16_f32 v125, v26, v27
    v_exp_f32 v28, v28
    v_smfmac_f32_16x16x64_bf16 v[128:131], v[136:139], v[112:119], v205
    v_exp_f32 v29, v29
    v_exp_f32 v30, v30
    v_exp_f32 v31, v31
    v_cvt_pk_bf16_f32 v126, v28, v29
    v_cvt_pk_bf16_f32 v127, v30, v31
    s_cmp_eq_u32 s49, 0
    s_cbranch_scc0 L_pr_41
    s_setprio 2
L_pr_41:
    v_mfma_f32_32x32x16_bf16 v[16:31], v[172:175], v[104:107], v[48:63]
    v_exp_f32 v0, v0
    v_exp_f32 v1, v1
    v_exp_f32 v2, v2
    v_exp_f32 v3, v3
    v_mfma_f32_32x32x16_bf16 v[16:31], v[176:179], v[108:111], v[16:31]
    buffer_load_dwordx4 v[156:159], v204, s[12:15], s77 offen
    v_cvt_pk_bf16_f32 v112, v0, v1
    v_cvt_pk_bf16_f32 v113, v2, v3
    v_exp_f32 v4, v4
    v_exp_f32 v5, v5
    v_exp_f32 v6, v6
    v_mfma_f32_32x32x16_bf16 v[80:95], v[164:167], v[120:123], v[80:95]
    v_exp_f32 v7, v7
    v_cvt_pk_bf16_f32 v114, v4, v5
    v_cvt_pk_bf16_f32 v115, v6, v7
    v_exp_f32 v8, v8
    v_exp_f32 v9, v9
    v_mfma_f32_32x32x16_bf16 v[80:95], v[168:171], v[124:127], v[80:95]
    buffer_load_dwordx4 v[160:163], v204, s[12:15], s77 offen offset:1024
    v_exp_f32 v10, v10
    v_exp_f32 v11, v11
    v_cvt_pk_bf16_f32 v116, v8, v9
    v_cvt_pk_bf16_f32 v117, v10, v11
    v_exp_f32 v12, v12
    v_smfmac_f32_16x16x64_bf16 v[132:135], v[136:139], v[120:127], v205
    v_exp_f32 v13, v13
    v_exp_f32 v14, v14
    v_exp_f32 v15, v15
    v_cvt_pk_bf16_f32 v118, v12, v13
    v_cvt_pk_bf16_f32 v119, v14, v15
    s_waitcnt vmcnt(8)
    v_mfma_f32_32x32x16_bf16 v[0:15], v[188:191], v[96:99], v[32:47]
    v_exp_f32 v16, v16
    v_exp_f32 v17, v17
    v_exp_f32 v18, v18
    v_exp_f32 v19, v19
    v_mfma_f32_32x32x16_bf16 v[0:15], v[192:195], v[100:103], v[0:15]
    buffer_load_dwordx4 v[164:167], v204, s[12:15], s77 offen offset:2048
    v_cvt_pk_bf16_f32 v120, v16, v17
    v_cvt_pk_bf16_f32 v121, v18, v19
    v_exp_f32 v20, v20
    v_exp_f32 v21, v21
    v_exp_f32 v22, v22
    v_mfma_f32_32x32x16_bf16 v[64:79], v[180:183], v[112:115], v[64:79]
    v_exp_f32 v23, v23
    v_cvt_pk_bf16_f32 v122, v20, v21
    v_cvt_pk_bf16_f32 v123, v22, v23
    v_exp_f32 v24, v24
    v_exp_f32 v25, v25
    v_mfma_f32_32x32x16_bf16 v[64:79], v[184:187], v[116:119], v[64:79]
    buffer_load_dwordx4 v[168:171], v204, s[12:15], s77 offen offset:3072
    s_add_u32 s77, s77, 4096
    s_and_b32 s77, s77, 0x1ffff
    v_exp_f32 v26, v26
    v_exp_f32 v27, v27
    v_cvt_pk_bf16_f32 v124, v24, v25
    v_cvt_pk_bf16_f32 v125, v26, v27
    v_exp_f32 v28, v28
    v_smfmac_f32_16x16x64_bf16 v[128:131], v[136:139], v[112:119], v205
    v_exp_f32 v29, v29
    v_exp_f32 v30, v30
    v_exp_f32 v31, v31
    v_cvt_pk_bf16_f32 v126, v28, v29
    v_cvt_pk_bf16_f32 v127, v30, v31
    v_mfma_f32_32x32x16_bf16 v[16:31], v[188:191], v[104:107], v[48:63]
    v_exp_f32 v0, v0
    v_exp_f32 v1, v1
    v_exp_f32 v2, v2
    v_exp_f32 v3, v3
    v_mfma_f32_32x32x16_bf16 v[16:31], v[192:195], v[108:111], v[16:31]
    buffer_load_dwordx4 v[172:175], v204, s[12:15], s77 offen
    v_cvt_pk_bf16_f32 v112, v0, v1
    v_cvt_pk_bf16_f32 v113, v2, v3
    v_exp_f32 v4, v4
    v_exp_f32 v5, v5
    v_exp_f32 v6, v6
    v_mfma_f32_32x32x16_bf16 v[80:95], v[180:183], v[120:123], v[80:95]
    v_exp_f32 v7, v7
    v_cvt_pk_bf16_f32 v114, v4, v5
    v_cvt_pk_bf16_f32 v115, v6, v7
    v_exp_f32 v8, v8
    v_exp_f32 v9, v9
    v_mfma_f32_32x32x16_bf16 v[80:95], v[184:187], v[124:127], v[80:95]
    buffer_load_dwordx4 v[176:179], v204, s[12:15], s77 offen offset:1024
    v_exp_f32 v10, v10
    v_exp_f32 v11, v11
    v_cvt_pk_bf16_f32 v116, v8, v9
    v_cvt_pk_bf16_f32 v117, v10, v11
    v_exp_f32 v12, v12
    v_smfmac_f32_16x16x64_bf16 v[132:135], v[136:139], v[120:127], v205
    v_exp_f32 v13, v13
    v_exp_f32 v14, v14
    v_exp_f32 v15, v15
    v_cvt_pk_bf16_f32 v118, v12, v13
    v_cvt_pk_bf16_f32 v119, v14, v15
    s_waitcnt vmcnt(8)
    v_mfma_f32_32x32x16_bf16 v[0:15], v[140:143], v[96:99], v[32:47]
    v_and_b32 v206, 15, v253
    v_lshlrev_b32 v206, 2, v206
    s_lshl_b32 s64, s52, 7
    v_add_u32 v206, s64, v206
    s_mov_b32 s65, 0x1308000
    buffer_load_dword v207, v206, s[12:15], s65 offen sc1
    v_exp_f32 v16, v16
    v_exp_f32 v17, v17
    v_exp_f32 v18, v18
    v_exp_f32 v19, v19
    v_mfma_f32_32x32x16_bf16 v[0:15], v[144:147], v[100:103], v[0:15]
    v_cvt_pk_bf16_f32 v120, v16, v17
    v_cvt_pk_bf16_f32 v121, v18, v19
    v_exp_f32 v20, v20
    v_exp_f32 v21, v21
    v_exp_f32 v22, v22
    v_mfma_f32_32x32x16_bf16 v[64:79], v[196:199], v[112:115], v[64:79]
    buffer_load_dwordx4 v[180:183], v204, s[12:15], s77 offen offset:2048
    v_exp_f32 v23, v23
    v_cvt_pk_bf16_f32 v122, v20, v21
    v_cvt_pk_bf16_f32 v123, v22, v23
    v_exp_f32 v24, v24
    v_exp_f32 v25, v25
    v_mfma_f32_32x32x16_bf16 v[64:79], v[200:203], v[116:119], v[64:79]
    buffer_load_dwordx4 v[184:187], v204, s[12:15], s77 offen offset:3072
    s_add_u32 s77, s77, 4096
    s_and_b32 s77, s77, 0x1ffff
    v_exp_f32 v26, v26
    v_exp_f32 v27, v27
    v_cvt_pk_bf16_f32 v124, v24, v25
    v_cvt_pk_bf16_f32 v125, v26, v27
    v_exp_f32 v28, v28
    v_smfmac_f32_16x16x64_bf16 v[128:131], v[136:139], v[112:119], v205
    v_exp_f32 v29, v29
    v_exp_f32 v30, v30
    v_exp_f32 v31, v31
    v_cvt_pk_bf16_f32 v126, v28, v29
    v_cvt_pk_bf16_f32 v127, v30, v31
    s_cmp_eq_u32 s49, 0
    s_cbranch_scc0 L_pr_42
    s_setprio 0
L_pr_42:
    v_mfma_f32_32x32x16_bf16 v[16:31], v[140:143], v[104:107], v[48:63]
    v_exp_f32 v0, v0
    v_exp_f32 v1, v1
    v_exp_f32 v2, v2
    v_exp_f32 v3, v3
    v_mfma_f32_32x32x16_bf16 v[16:31], v[144:147], v[108:111], v[16:31]
    buffer_load_dwordx4 v[188:191], v204, s[12:15], s77 offen
    v_cvt_pk_bf16_f32 v112, v0, v1
    v_cvt_pk_bf16_f32 v113, v2, v3
    v_exp_f32 v4, v4
    v_exp_f32 v5, v5
    v_exp_f32 v6, v6
    v_mfma_f32_32x32x16_bf16 v[80:95], v[196:199], v[120:123], v[80:95]
    v_exp_f32 v7, v7
    v_cvt_pk_bf16_f32 v114, v4, v5
    v_cvt_pk_bf16_f32 v115, v6, v7
    v_exp_f32 v8, v8
    v_exp_f32 v9, v9
    v_mfma_f32_32x32x16_bf16 v[80:95], v[200:203], v[124:127], v[80:95]
    buffer_load_dwordx4 v[192:195], v204, s[12:15], s77 offen offset:1024
    v_exp_f32 v10, v10
    v_exp_f32 v11, v11
    v_cvt_pk_bf16_f32 v116, v8, v9
    v_cvt_pk_bf16_f32 v117, v10, v11
    v_exp_f32 v12, v12
    v_smfmac_f32_16x16x64_bf16 v[132:135], v[136:139], v[120:127], v205
    v_exp_f32 v13, v13
    v_exp_f32 v14, v14
    v_exp_f32 v15, v15
    v_cvt_pk_bf16_f32 v118, v12, v13
    v_cvt_pk_bf16_f32 v119, v14, v15
    s_waitcnt vmcnt(9)
    v_mfma_f32_32x32x16_bf16 v[0:15], v[156:159], v[96:99], v[32:47]
    v_exp_f32 v16, v16
    v_exp_f32 v17, v17
    v_exp_f32 v18, v18
    v_exp_f32 v19, v19
    v_mfma_f32_32x32x16_bf16 v[0:15], v[160:163], v[100:103], v[0:15]
    buffer_load_dwordx4 v[196:199], v204, s[12:15], s77 offen offset:2048
    v_cvt_pk_bf16_f32 v120, v16, v17
    v_cvt_pk_bf16_f32 v121, v18, v19
    v_exp_f32 v20, v20
    v_exp_f32 v21, v21
    v_exp_f32 v22, v22
    v_mfma_f32_32x32x16_bf16 v[64:79], v[148:151], v[112:115], v[64:79]
    v_exp_f32 v23, v23
    v_cvt_pk_bf16_f32 v122, v20, v21
    v_cvt_pk_bf16_f32 v123, v22, v23
    v_exp_f32 v24, v24
    v_exp_f32 v25, v25
    v_mfma_f32_32x32x16_bf16 v[64:79], v[152:155], v[116:119], v[64:79]
    buffer_load_dwordx4 v[200:203], v204, s[12:15], s77 offen offset:3072
    s_add_u32 s77, s77, 4096
    s_and_b32 s77, s77, 0x1ffff
    v_exp_f32 v26, v26
    v_exp_f32 v27, v27
    v_cvt_pk_bf16_f32 v124, v24, v25
    v_cvt_pk_bf16_f32 v125, v26, v27
    v_exp_f32 v28, v28
    v_smfmac_f32_16x16x64_bf16 v[128:131], v[136:139], v[112:119], v205
    v_exp_f32 v29, v29
    v_exp_f32 v30, v30
    v_exp_f32 v31, v31
    v_cvt_pk_bf16_f32 v126, v28, v29
    v_cvt_pk_bf16_f32 v127, v30, v31
    s_cmp_eq_u32 s49, 0
    s_cbranch_scc0 L_pr_43
    s_setprio 2
L_pr_43:
    s_waitcnt vmcnt(6)
    v_cmp_ne_u32 vcc, 1, v207
    s_cbranch_vccz L_flagok_44
    s_mov_b32 s71, 0
    s_mov_b32 s68, 0x1308000
L_poll_45:
    buffer_load_dword v207, v206, s[12:15], s68 offen sc1
    s_waitcnt vmcnt(0)
    v_cmp_ne_u32 vcc, 1, v207
    s_cbranch_vccz L_polled_46
    s_add_u32 s71, s71, 1
    s_cmp_ge_u32 s71, 0x10000
    s_cbranch_scc1 L_polled_46
    s_sleep 1
    s_branch L_poll_45
L_polled_46:
L_flagok_44:
    v_mfma_f32_32x32x16_bf16 v[16:31], v[156:159], v[104:107], v[48:63]
    v_exp_f32 v0, v0
    v_exp_f32 v1, v1
    v_exp_f32 v2, v2
    v_exp_f32 v3, v3
    v_mfma_f32_32x32x16_bf16 v[16:31], v[160:163], v[108:111], v[16:31]
    buffer_load_dwordx4 v[140:143], v204, s[12:15], s77 offen
    v_cvt_pk_bf16_f32 v112, v0, v1
    v_cvt_pk_bf16_f32 v113, v2, v3
    v_exp_f32 v4, v4
    v_exp_f32 v5, v5
    v_exp_f32 v6, v6
    v_mfma_f32_32x32x16_bf16 v[80:95], v[148:151], v[120:123], v[80:95]
    v_exp_f32 v7, v7
    v_cvt_pk_bf16_f32 v114, v4, v5
    v_cvt_pk_bf16_f32 v115, v6, v7
    v_exp_f32 v8, v8
    v_exp_f32 v9, v9
    v_mfma_f32_32x32x16_bf16 v[80:95], v[152:155], v[124:127], v[80:95]
    buffer_load_dwordx4 v[144:147], v204, s[12:15], s77 offen offset:1024
    v_exp_f32 v10, v10
    v_exp_f32 v11, v11
    v_cvt_pk_bf16_f32 v116, v8, v9
    v_cvt_pk_bf16_f32 v117, v10, v11
    v_exp_f32 v12, v12
    v_smfmac_f32_16x16x64_bf16 v[132:135], v[136:139], v[120:127], v205
    v_exp_f32 v13, v13
    v_exp_f32 v14, v14
    v_exp_f32 v15, v15
    v_cvt_pk_bf16_f32 v118, v12, v13
    v_cvt_pk_bf16_f32 v119, v14, v15
    v_mfma_f32_32x32x16_bf16 v[0:15], v[172:175], v[96:99], v[32:47]
    buffer_load_dwordx4 v[240:243], v254, s[12:15], s80 offen sc1
    s_add_u32 s80, s80, 8192
    buffer_load_dwordx4 v[244:247], v254, s[12:15], s80 offen sc1
    s_add_u32 s80, s80, 8192
    v_exp_f32 v16, v16
    v_exp_f32 v17, v17
    v_exp_f32 v18, v18
    v_exp_f32 v19, v19
    v_mfma_f32_32x32x16_bf16 v[0:15], v[176:179], v[100:103], v[0:15]
    v_and_b32 v207, 31, v253
    v_lshlrev_b32 v207, 2, v207
    v_lshl_add_u32 v207, v255, 7, v207
    buffer_load_dword v208, v207, s[12:15], s73 offen sc1
    v_cvt_pk_bf16_f32 v120, v16, v17
    v_cvt_pk_bf16_f32 v121, v18, v19
    v_exp_f32 v20, v20
    v_exp_f32 v21, v21
    v_exp_f32 v22, v22
    v_mfma_f32_32x32x16_bf16 v[64:79], v[164:167], v[112:115], v[64:79]
    buffer_load_dword v209, v207, s[12:15], s73 offen offset:256 sc1
    buffer_load_dword v210, v207, s[12:15], s73 offen offset:512 sc1
    v_exp_f32 v23, v23
    v_cvt_pk_bf16_f32 v122, v20, v21
    v_cvt_pk_bf16_f32 v123, v22, v23
    v_exp_f32 v24, v24
    v_exp_f32 v25, v25
    v_mfma_f32_32x32x16_bf16 v[64:79], v[168:171], v[116:119], v[64:79]
    buffer_load_dword v211, v207, s[12:15], s73 offen offset:768 sc1
    buffer_load_dwordx4 v[148:151], v204, s[12:15], s77 offen offset:2048
    v_exp_f32 v26, v26
    v_exp_f32 v27, v27
    v_cvt_pk_bf16_f32 v124, v24, v25
    v_cvt_pk_bf16_f32 v125, v26, v27
    v_exp_f32 v28, v28
    v_smfmac_f32_16x16x64_bf16 v[128:131], v[136:139], v[112:119], v205
    buffer_load_dwordx4 v[152:155], v204, s[12:15], s77 offen offset:3072
    s_add_u32 s77, s77, 4096
    s_and_b32 s77, s77, 0x1ffff
    v_exp_f32 v29, v29
    v_exp_f32 v30, v30
    v_exp_f32 v31, v31
    v_cvt_pk_bf16_f32 v126, v28, v29
    v_cvt_pk_bf16_f32 v127, v30, v31
    v_mfma_f32_32x32x16_bf16 v[16:31], v[172:175], v[104:107], v[48:63]
    v_exp_f32 v0, v0
    v_exp_f32 v1, v1
    v_exp_f32 v2, v2
    v_exp_f32 v3, v3
    v_mfma_f32_32x32x16_bf16 v[16:31], v[176:179], v[108:111], v[16:31]
    buffer_load_dwordx4 v[156:159], v204, s[12:15], s77 offen
    v_cvt_pk_bf16_f32 v112, v0, v1
    v_cvt_pk_bf16_f32 v113, v2, v3
    v_exp_f32 v4, v4
    v_exp_f32 v5, v5
    v_exp_f32 v6, v6
    v_mfma_f32_32x32x16_bf16 v[80:95], v[164:167], v[120:123], v[80:95]
    v_exp_f32 v7, v7
    v_cvt_pk_bf16_f32 v114, v4, v5
    v_cvt_pk_bf16_f32 v115, v6, v7
    v_exp_f32 v8, v8
    v_exp_f32 v9, v9
    v_mfma_f32_32x32x16_bf16 v[80:95], v[168:171], v[124:127], v[80:95]
    buffer_load_dwordx4 v[160:163], v204, s[12:15], s77 offen offset:1024
    v_exp_f32 v10, v10
    v_exp_f32 v11, v11
    v_cvt_pk_bf16_f32 v116, v8, v9
    v_cvt_pk_bf16_f32 v117, v10, v11
    v_exp_f32 v12, v12
    v_smfmac_f32_16x16x64_bf16 v[132:135], v[136:139], v[120:127], v205
    v_exp_f32 v13, v13
    v_exp_f32 v14, v14
    v_exp_f32 v15, v15
    v_cvt_pk_bf16_f32 v118, v12, v13
    v_cvt_pk_bf16_f32 v119, v14, v15
    s_waitcnt vmcnt(14)
    v_mfma_f32_32x32x16_bf16 v[0:15], v[188:191], v[96:99], v[32:47]
    buffer_load_dwordx4 v[216:219], v254, s[12:15], s80 offen sc1
    s_add_u32 s80, s80, 8192
    buffer_load_dwordx4 v[220:223], v254, s[12:15], s80 offen sc1
    s_add_u32 s80, s80, 8192
    v_exp_f32 v16, v16
    v_exp_f32 v17, v17
    v_exp_f32 v18, v18
    v_exp_f32 v19, v19
    v_mfma_f32_32x32x16_bf16 v[0:15], v[192:195], v[100:103], v[0:15]
    buffer_load_dword v212, v207, s[12:15], s73 offen offset:1024 sc1
    buffer_load_dword v213, v207, s[12:15], s73 offen offset:1280 sc1
    v_cvt_pk_bf16_f32 v120, v16, v17
    v_cvt_pk_bf16_f32 v121, v18, v19
    v_exp_f32 v20, v20
    v_exp_f32 v21, v21
    v_exp_f32 v22, v22
    v_mfma_f32_32x32x16_bf16 v[64:79], v[180:183], v[112:115], v[64:79]
    buffer_load_dword v214, v207, s[12:15], s73 offen offset:1536 sc1
    v_exp_f32 v23, v23
    v_cvt_pk_bf16_f32 v122, v20, v21
    v_cvt_pk_bf16_f32 v123, v22, v23
    v_exp_f32 v24, v24
    v_exp_f32 v25, v25
    v_mfma_f32_32x32x16_bf16 v[64:79], v[184:187], v[116:119], v[64:79]
    buffer_load_dword v215, v207, s[12:15], s73 offen offset:1792 sc1
    buffer_load_dwordx4 v[164:167], v204, s[12:15], s77 offen offset:2048
    v_exp_f32 v26, v26
    v_exp_f32 v27, v27
    v_cvt_pk_bf16_f32 v124, v24, v25
    v_cvt_pk_bf16_f32 v125, v26, v27
    v_exp_f32 v28, v28
    v_smfmac_f32_16x16x64_bf16 v[128:131], v[136:139], v[112:119], v205
    buffer_load_dwordx4 v[168:171], v204, s[12:15], s77 offen offset:3072
    s_add_u32 s77, s77, 4096
    s_and_b32 s77, s77, 0x1ffff
    v_exp_f32 v29, v29
    v_exp_f32 v30, v30
    v_exp_f32 v31, v31
    v_cvt_pk_bf16_f32 v126, v28, v29
    v_cvt_pk_bf16_f32 v127, v30, v31
    v_mfma_f32_32x32x16_bf16 v[16:31], v[188:191], v[104:107], v[48:63]
    v_exp_f32 v0, v0
    v_exp_f32 v1, v1
    v_exp_f32 v2, v2
    v_exp_f32 v3, v3
    v_mfma_f32_32x32x16_bf16 v[16:31], v[192:195], v[108:111], v[16:31]
    buffer_load_dwordx4 v[172:175], v204, s[12:15], s77 offen
    v_cvt_pk_bf16_f32 v112, v0, v1
    v_cvt_pk_bf16_f32 v113, v2, v3
    v_exp_f32 v4, v4
    v_exp_f32 v5, v5
    v_exp_f32 v6, v6
    v_mfma_f32_32x32x16_bf16 v[80:95], v[180:183], v[120:123], v[80:95]
    v_exp_f32 v7, v7
    v_cvt_pk_bf16_f32 v114, v4, v5
    v_cvt_pk_bf16_f32 v115, v6, v7
    v_exp_f32 v8, v8
    v_exp_f32 v9, v9
    v_mfma_f32_32x32x16_bf16 v[80:95], v[184:187], v[124:127], v[80:95]
    buffer_load_dwordx4 v[176:179], v204, s[12:15], s77 offen offset:1024
    v_exp_f32 v10, v10
    v_exp_f32 v11, v11
    v_cvt_pk_bf16_f32 v116, v8, v9
    v_cvt_pk_bf16_f32 v117, v10, v11
    v_exp_f32 v12, v12
    v_smfmac_f32_16x16x64_bf16 v[132:135], v[136:139], v[120:127], v205
    v_exp_f32 v13, v13
    v_exp_f32 v14, v14
    v_exp_f32 v15, v15
    v_cvt_pk_bf16_f32 v118, v12, v13
    v_cvt_pk_bf16_f32 v119, v14, v15
    s_waitcnt vmcnt(20)
    s_waitcnt vmcnt(18)
    v_mfma_f32_32x32x16_bf16 v[224:239], v[240:243], v[248:251], 0
    v_exp_f32 v16, v16
    v_exp_f32 v17, v17
    v_exp_f32 v18, v18
    v_mfma_f32_32x32x16_bf16 v[224:239], v[244:247], v[248:251], v[224:239]
    buffer_load_dwordx4 v[240:243], v254, s[12:15], s80 offen sc1
    s_add_u32 s80, s80, 8192
    v_exp_f32 v19, v19
    v_cvt_pk_bf16_f32 v120, v16, v17
    v_cvt_pk_bf16_f32 v121, v18, v19
    v_mfma_f32_32x32x16_bf16 v[0:15], v[140:143], v[96:99], v[32:47]
    buffer_load_dwordx4 v[244:247], v254, s[12:15], s80 offen sc1
    s_add_u32 s80, s80, 8192
    v_exp_f32 v20, v20
    v_exp_f32 v21, v21
    v_exp_f32 v22, v22
    v_exp_f32 v23, v23
    v_mfma_f32_32x32x16_bf16 v[0:15], v[144:147], v[100:103], v[0:15]
    v_cvt_pk_bf16_f32 v122, v20, v21
    v_cvt_pk_bf16_f32 v123, v22, v23
    v_exp_f32 v24, v24
    v_mfma_f32_32x32x16_bf16 v[64:79], v[196:199], v[112:115], v[64:79]
    buffer_load_dwordx4 v[180:183], v204, s[12:15], s77 offen offset:2048
    v_exp_f32 v25, v25
    v_exp_f32 v26, v26
    v_exp_f32 v27, v27
    v_cvt_pk_bf16_f32 v124, v24, v25
    v_mfma_f32_32x32x16_bf16 v[64:79], v[200:203], v[116:119], v[64:79]
    buffer_load_dwordx4 v[184:187], v204, s[12:15], s77 offen offset:3072
    s_add_u32 s77, s77, 4096
    s_and_b32 s77, s77, 0x1ffff
    v_cvt_pk_bf16_f32 v125, v26, v27
    v_exp_f32 v28, v28
    v_exp_f32 v29, v29
    v_smfmac_f32_16x16x64_bf16 v[128:131], v[136:139], v[112:119], v205
    v_exp_f32 v30, v30
    v_exp_f32 v31, v31
    v_cvt_pk_bf16_f32 v126, v28, v29
    v_cvt_pk_bf16_f32 v127, v30, v31
    s_cmp_eq_u32 s49, 0
    s_cbranch_scc0 L_pr_47
    s_setprio 0
L_pr_47:
    v_mfma_f32_32x32x16_bf16 v[16:31], v[140:143], v[104:107], v[48:63]
    v_exp_f32 v0, v0
    v_exp_f32 v1, v1
    v_exp_f32 v2, v2
    v_exp_f32 v3, v3
    v_mfma_f32_32x32x16_bf16 v[16:31], v[144:147], v[108:111], v[16:31]
    buffer_load_dwordx4 v[188:191], v204, s[12:15], s77 offen
    v_cvt_pk_bf16_f32 v112, v0, v1
    v_cvt_pk_bf16_f32 v113, v2, v3
    v_exp_f32 v4, v4
    v_exp_f32 v5, v5
    v_exp_f32 v6, v6
    v_mfma_f32_32x32x16_bf16 v[80:95], v[196:199], v[120:123], v[80:95]
    v_exp_f32 v7, v7
    v_cvt_pk_bf16_f32 v114, v4, v5
    v_cvt_pk_bf16_f32 v115, v6, v7
    v_exp_f32 v8, v8
    v_exp_f32 v9, v9
    v_mfma_f32_32x32x16_bf16 v[80:95], v[200:203], v[124:127], v[80:95]
    buffer_load_dwordx4 v[192:195], v204, s[12:15], s77 offen offset:1024
    v_exp_f32 v10, v10
    v_exp_f32 v11, v11
    v_cvt_pk_bf16_f32 v116, v8, v9
    v_cvt_pk_bf16_f32 v117, v10, v11
    v_exp_f32 v12, v12
    v_smfmac_f32_16x16x64_bf16 v[132:135], v[136:139], v[120:127], v205
    v_exp_f32 v13, v13
    v_exp_f32 v14, v14
    v_exp_f32 v15, v15
    v_cvt_pk_bf16_f32 v118, v12, v13
    v_cvt_pk_bf16_f32 v119, v14, v15
    s_waitcnt vmcnt(16)
    s_waitcnt vmcnt(14)
    v_mfma_f32_32x32x16_bf16 v[224:239], v[216:219], v[248:251], v[224:239]
    v_exp_f32 v16, v16
    v_exp_f32 v17, v17
    v_exp_f32 v18, v18
    v_mfma_f32_32x32x16_bf16 v[224:239], v[220:223], v[248:251], v[224:239]
    buffer_load_dwordx4 v[216:219], v254, s[12:15], s80 offen sc1
    s_add_u32 s80, s80, 8192
    v_exp_f32 v19, v19
    v_cvt_pk_bf16_f32 v120, v16, v17
    v_cvt_pk_bf16_f32 v121, v18, v19
    v_mfma_f32_32x32x16_bf16 v[0:15], v[156:159], v[96:99], v[32:47]
    buffer_load_dwordx4 v[220:223], v254, s[12:15], s80 offen sc1
    s_add_u32 s80, s80, 8192
    v_exp_f32 v20, v20
    v_exp_f32 v21, v21
    v_exp_f32 v22, v22
    v_exp_f32 v23, v23
    v_mfma_f32_32x32x16_bf16 v[0:15], v[160:163], v[100:103], v[0:15]
    v_cvt_pk_bf16_f32 v122, v20, v21
    v_cvt_pk_bf16_f32 v123, v22, v23
    v_exp_f32 v24, v24
    v_mfma_f32_32x32x16_bf16 v[64:79], v[148:151], v[112:115], v[64:79]
    buffer_load_dwordx4 v[196:199], v204, s[12:15], s77 offen offset:2048
    v_exp_f32 v25, v25
    v_exp_f32 v26, v26
    v_exp_f32 v27, v27
    v_cvt_pk_bf16_f32 v124, v24, v25
    v_mfma_f32_32x32x16_bf16 v[64:79], v[152:155], v[116:119], v[64:79]
    buffer_load_dwordx4 v[200:203], v204, s[12:15], s77 offen offset:3072
    s_add_u32 s77, s77, 4096
    s_and_b32 s77, s77, 0x1ffff
    v_cvt_pk_bf16_f32 v125, v26, v27
    v_exp_f32 v28, v28
    v_exp_f32 v29, v29
    v_smfmac_f32_16x16x64_bf16 v[128:131], v[136:139], v[112:119], v205
    v_exp_f32 v30, v30
    v_exp_f32 v31, v31
    v_cvt_pk_bf16_f32 v126, v28, v29
    v_cvt_pk_bf16_f32 v127, v30, v31
    s_cmp_eq_u32 s49, 0
    s_cbranch_scc0 L_pr_48
    s_setprio 2
L_pr_48:
    v_mfma_f32_32x32x16_bf16 v[16:31], v[156:159], v[104:107], v[48:63]
    v_exp_f32 v0, v0
    v_exp_f32 v1, v1
    v_exp_f32 v2, v2
    v_exp_f32 v3, v3
    v_mfma_f32_32x32x16_bf16 v[16:31], v[160:163], v[108:111], v[16:31]
    buffer_load_dwordx4 v[140:143], v204, s[12:15], s77 offen
    v_cvt_pk_bf16_f32 v112, v0, v1
    v_cvt_pk_bf16_f32 v113, v2, v3
    v_exp_f32 v4, v4
    v_exp_f32 v5, v5
    v_exp_f32 v6, v6
    v_mfma_f32_32x32x16_bf16 v[80:95], v[148:151], v[120:123], v[80:95]
    v_exp_f32 v7, v7
    v_cvt_pk_bf16_f32 v114, v4, v5
    v_cvt_pk_bf16_f32 v115, v6, v7
    v_exp_f32 v8, v8
    v_exp_f32 v9, v9
    v_mfma_f32_32x32x16_bf16 v[80:95], v[152:155], v[124:127], v[80:95]
    buffer_load_dwordx4 v[144:147], v204, s[12:15], s77 offen offset:1024
    v_exp_f32 v10, v10
    v_exp_f32 v11, v11
    v_cvt_pk_bf16_f32 v116, v8, v9
    v_cvt_pk_bf16_f32 v117, v10, v11
    v_exp_f32 v12, v12
    v_smfmac_f32_16x16x64_bf16 v[132:135], v[136:139], v[120:127], v205
    v_exp_f32 v13, v13
    v_exp_f32 v14, v14
    v_exp_f32 v15, v15
    v_cvt_pk_bf16_f32 v118, v12, v13
    v_cvt_pk_bf16_f32 v119, v14, v15
    s_waitcnt vmcnt(12)
    s_waitcnt vmcnt(10)
    v_mfma_f32_32x32x16_bf16 v[224:239], v[240:243], v[248:251], v[224:239]
    v_exp_f32 v16, v16
    v_exp_f32 v17, v17
    v_exp_f32 v18, v18
    v_mfma_f32_32x32x16_bf16 v[224:239], v[244:247], v[248:251], v[224:239]
    buffer_load_dwordx4 v[240:243], v254, s[12:15], s80 offen sc1
    s_add_u32 s80, s80, 8192
    v_exp_f32 v19, v19
    v_cvt_pk_bf16_f32 v120, v16, v17
    v_cvt_pk_bf16_f32 v121, v18, v19
    v_mfma_f32_32x32x16_bf16 v[0:15], v[172:175], v[96:99], v[32:47]
    buffer_load_dwordx4 v[244:247], v254, s[12:15], s80 offen sc1
    s_add_u32 s80, s80, 8192
    v_exp_f32 v20, v20
    v_exp_f32 v21, v21
    v_exp_f32 v22, v22
    v_exp_f32 v23, v23
    v_mfma_f32_32x32x16_bf16 v[0:15], v[176:179], v[100:103], v[0:15]
    v_cvt_pk_bf16_f32 v122, v20, v21
    v_cvt_pk_bf16_f32 v123, v22, v23
    v_exp_f32 v24, v24
    v_mfma_f32_32x32x16_bf16 v[64:79], v[164:167], v[112:115], v[64:79]
    buffer_load_dwordx4 v[148:151], v204, s[12:15], s77 offen offset:2048
    v_exp_f32 v25, v25
    v_exp_f32 v26, v26
    v_exp_f32 v27, v27
    v_cvt_pk_bf16_f32 v124, v24, v25
    v_mfma_f32_32x32x16_bf16 v[64:79], v[168:171], v[116:119], v[64:79]
    buffer_load_dwordx4 v[152:155], v204, s[12:15], s77 offen offset:3072
    s_add_u32 s77, s77, 4096
    s_and_b32 s77, s77, 0x1ffff
    v_cvt_pk_bf16_f32 v125, v26, v27
    v_exp_f32 v28, v28
    v_exp_f32 v29, v29
    v_smfmac_f32_16x16x64_bf16 v[128:131], v[136:139], v[112:119], v205
    v_exp_f32 v30, v30
    v_exp_f32 v31, v31
    v_cvt_pk_bf16_f32 v126, v28, v29
    v_cvt_pk_bf16_f32 v127, v30, v31
    v_mfma_f32_32x32x16_bf16 v[16:31], v[172:175], v[104:107], v[48:63]
    v_exp_f32 v0, v0
    v_exp_f32 v1, v1
    v_exp_f32 v2, v2
    v_exp_f32 v3, v3
    v_mfma_f32_32x32x16_bf16 v[16:31], v[176:179], v[108:111], v[16:31]
    buffer_load_dwordx4 v[156:159], v204, s[12:15], s77 offen
    v_cvt_pk_bf16_f32 v112, v0, v1
    v_cvt_pk_bf16_f32 v113, v2, v3
    v_exp_f32 v4, v4
    v_exp_f32 v5, v5
    v_exp_f32 v6, v6
    v_mfma_f32_32x32x16_bf16 v[80:95], v[164:167], v[120:123], v[80:95]
    v_exp_f32 v7, v7
    v_cvt_pk_bf16_f32 v114, v4, v5
    v_cvt_pk_bf16_f32 v115, v6, v7
    v_exp_f32 v8, v8
    v_exp_f32 v9, v9
    v_mfma_f32_32x32x16_bf16 v[80:95], v[168:171], v[124:127], v[80:95]
    buffer_load_dwordx4 v[160:163], v204, s[12:15], s77 offen offset:1024
    v_exp_f32 v10, v10
    v_exp_f32 v11, v11
    v_cvt_pk_bf16_f32 v116, v8, v9
    v_cvt_pk_bf16_f32 v117, v10, v11
    v_exp_f32 v12, v12
    v_smfmac_f32_16x16x64_bf16 v[132:135], v[136:139], v[120:127], v205
    v_exp_f32 v13, v13
    v_exp_f32 v14, v14
    v_exp_f32 v15, v15
    v_cvt_pk_bf16_f32 v118, v12, v13
    v_cvt_pk_bf16_f32 v119, v14, v15
    s_waitcnt vmcnt(12)
    s_waitcnt vmcnt(10)
    v_mfma_f32_32x32x16_bf16 v[224:239], v[216:219], v[248:251], v[224:239]
    v_exp_f32 v16, v16
    v_exp_f32 v17, v17
    v_exp_f32 v18, v18
    v_mfma_f32_32x32x16_bf16 v[224:239], v[220:223], v[248:251], v[224:239]
    buffer_load_dwordx4 v[216:219], v254, s[12:15], s80 offen sc1
    s_add_u32 s80, s80, 8192
    v_exp_f32 v19, v19
    v_cvt_pk_bf16_f32 v120, v16, v17
    v_cvt_pk_bf16_f32 v121, v18, v19
    v_mfma_f32_32x32x16_bf16 v[0:15], v[188:191], v[96:99], v[32:47]
    buffer_load_dwordx4 v[220:223], v254, s[12:15], s80 offen sc1
    s_add_u32 s80, s80, 8192
    v_exp_f32 v20, v20
    v_exp_f32 v21, v21
    v_exp_f32 v22, v22
    v_exp_f32 v23, v23
    v_mfma_f32_32x32x16_bf16 v[0:15], v[192:195], v[100:103], v[0:15]
    v_cvt_pk_bf16_f32 v122, v20, v21
    v_cvt_pk_bf16_f32 v123, v22, v23
    v_exp_f32 v24, v24
    v_mfma_f32_32x32x16_bf16 v[64:79], v[180:183], v[112:115], v[64:79]
    buffer_load_dwordx4 v[164:167], v204, s[12:15], s77 offen offset:2048
    v_exp_f32 v25, v25
    v_exp_f32 v26, v26
    v_exp_f32 v27, v27
    v_cvt_pk_bf16_f32 v124, v24, v25
    v_mfma_f32_32x32x16_bf16 v[64:79], v[184:187], v[116:119], v[64:79]
    buffer_load_dwordx4 v[168:171], v204, s[12:15], s77 offen offset:3072
    s_add_u32 s77, s77, 4096
    s_and_b32 s77, s77, 0x1ffff
    v_cvt_pk_bf16_f32 v125, v26, v27
    v_exp_f32 v28, v28
    v_exp_f32 v29, v29
    v_smfmac_f32_16x16x64_bf16 v[128:131], v[136:139], v[112:119], v205
    v_exp_f32 v30, v30
    v_exp_f32 v31, v31
    v_cvt_pk_bf16_f32 v126, v28, v29
    v_cvt_pk_bf16_f32 v127, v30, v31
    s_cmp_eq_u32 s49, 0
    s_cbranch_scc0 L_pr_49
    s_setprio 0
L_pr_49:
    v_mfma_f32_32x32x16_bf16 v[16:31], v[188:191], v[104:107], v[48:63]
    v_exp_f32 v0, v0
    v_exp_f32 v1, v1
    v_exp_f32 v2, v2
    v_exp_f32 v3, v3
    v_mfma_f32_32x32x16_bf16 v[16:31], v[192:195], v[108:111], v[16:31]
    buffer_load_dwordx4 v[172:175], v204, s[12:15], s77 offen
    v_cvt_pk_bf16_f32 v112, v0, v1
    v_cvt_pk_bf16_f32 v113, v2, v3
    v_exp_f32 v4, v4
    v_exp_f32 v5, v5
    v_exp_f32 v6, v6
    v_mfma_f32_32x32x16_bf16 v[80:95], v[180:183], v[120:123], v[80:95]
    v_exp_f32 v7, v7
    v_cvt_pk_bf16_f32 v114, v4, v5
    v_cvt_pk_bf16_f32 v115, v6, v7
    v_exp_f32 v8, v8
    v_exp_f32 v9, v9
    v_mfma_f32_32x32x16_bf16 v[80:95], v[184:187], v[124:127], v[80:95]
    buffer_load_dwordx4 v[176:179], v204, s[12:15], s77 offen offset:1024
    v_exp_f32 v10, v10
    v_exp_f32 v11, v11
    v_cvt_pk_bf16_f32 v116, v8, v9
    v_cvt_pk_bf16_f32 v117, v10, v11
    v_exp_f32 v12, v12
    v_smfmac_f32_16x16x64_bf16 v[132:135], v[136:139], v[120:127], v205
    v_exp_f32 v13, v13
    v_exp_f32 v14, v14
    v_exp_f32 v15, v15
    v_cvt_pk_bf16_f32 v118, v12, v13
    v_cvt_pk_bf16_f32 v119, v14, v15
    s_waitcnt vmcnt(12)
    s_waitcnt vmcnt(10)
    v_mfma_f32_32x32x16_bf16 v[224:239], v[240:243], v[248:251], v[224:239]
    v_exp_f32 v16, v16
    v_exp_f32 v17, v17
    v_exp_f32 v18, v18
    v_mfma_f32_32x32x16_bf16 v[224:239], v[244:247], v[248:251], v[224:239]
    buffer_load_dwordx4 v[240:243], v254, s[12:15], s80 offen sc1
    s_add_u32 s80, s80, 8192
    v_exp_f32 v19, v19
    v_cvt_pk_bf16_f32 v120, v16, v17
    v_cvt_pk_bf16_f32 v121, v18, v19
    v_mfma_f32_32x32x16_bf16 v[0:15], v[140:143], v[96:99], v[32:47]
    buffer_load_dwordx4 v[244:247], v254, s[12:15], s80 offen sc1
    s_add_u32 s80, s80, 8192
    v_exp_f32 v20, v20
    v_exp_f32 v21, v21
    v_exp_f32 v22, v22
    v_exp_f32 v23, v23
    v_mfma_f32_32x32x16_bf16 v[0:15], v[144:147], v[100:103], v[0:15]
    v_cvt_pk_bf16_f32 v122, v20, v21
    v_cvt_pk_bf16_f32 v123, v22, v23
    v_exp_f32 v24, v24
    v_mfma_f32_32x32x16_bf16 v[64:79], v[196:199], v[112:115], v[64:79]
    buffer_load_dwordx4 v[180:183], v204, s[12:15], s77 offen offset:2048
    v_exp_f32 v25, v25
    v_exp_f32 v26, v26
    v_exp_f32 v27, v27
    v_cvt_pk_bf16_f32 v124, v24, v25
    v_mfma_f32_32x32x16_bf16 v[64:79], v[200:203], v[116:119], v[64:79]
    buffer_load_dwordx4 v[184:187], v204, s[12:15], s77 offen offset:3072
    s_add_u32 s77, s77, 4096
    s_and_b32 s77, s77, 0x1ffff
    v_cvt_pk_bf16_f32 v125, v26, v27
    v_exp_f32 v28, v28
    v_exp_f32 v29, v29
    v_smfmac_f32_16x16x64_bf16 v[128:131], v[136:139], v[112:119], v205
    v_exp_f32 v30, v30
    v_exp_f32 v31, v31
    v_cvt_pk_bf16_f32 v126, v28, v29
    v_cvt_pk_bf16_f32 v127, v30, v31
    s_cmp_eq_u32 s49, 0
    s_cbranch_scc0 L_pr_50
    s_setprio 2
L_pr_50:
    v_mfma_f32_32x32x16_bf16 v[16:31], v[140:143], v[104:107], v[48:63]
    v_exp_f32 v0, v0
    v_exp_f32 v1, v1
    v_exp_f32 v2, v2
    v_exp_f32 v3, v3
    v_mfma_f32_32x32x16_bf16 v[16:31], v[144:147], v[108:111], v[16:31]
    buffer_load_dwordx4 v[188:191], v204, s[12:15], s77 offen
    v_cvt_pk_bf16_f32 v112, v0, v1
    v_cvt_pk_bf16_f32 v113, v2, v3
    v_exp_f32 v4, v4
    v_exp_f32 v5, v5
    v_exp_f32 v6, v6
    v_mfma_f32_32x32x16_bf16 v[80:95], v[196:199], v[120:123], v[80:95]
    v_exp_f32 v7, v7
    v_cvt_pk_bf16_f32 v114, v4, v5
    v_cvt_pk_bf16_f32 v115, v6, v7
    v_exp_f32 v8, v8
    v_exp_f32 v9, v9
    v_mfma_f32_32x32x16_bf16 v[80:95], v[200:203], v[124:127], v[80:95]
    buffer_load_dwordx4 v[192:195], v204, s[12:15], s77 offen offset:1024
    v_exp_f32 v10, v10
    v_exp_f32 v11, v11
    v_cvt_pk_bf16_f32 v116, v8, v9
    v_cvt_pk_bf16_f32 v117, v10, v11
    v_exp_f32 v12, v12
    v_smfmac_f32_16x16x64_bf16 v[132:135], v[136:139], v[120:127], v205
    v_exp_f32 v13, v13
    v_exp_f32 v14, v14
    v_exp_f32 v15, v15
    v_cvt_pk_bf16_f32 v118, v12, v13
    v_cvt_pk_bf16_f32 v119, v14, v15
    s_waitcnt vmcnt(12)
    s_waitcnt vmcnt(10)
    v_mfma_f32_32x32x16_bf16 v[224:239], v[216:219], v[248:251], v[224:239]
    v_exp_f32 v16, v16
    v_exp_f32 v17, v17
    v_exp_f32 v18, v18
    v_mfma_f32_32x32x16_bf16 v[224:239], v[220:223], v[248:251], v[224:239]
    buffer_load_dwordx4 v[216:219], v254, s[12:15], s80 offen sc1
    s_add_u32 s80, s80, 8192
    v_exp_f32 v19, v19
    v_cvt_pk_bf16_f32 v120, v16, v17
    v_cvt_pk_bf16_f32 v121, v18, v19
    v_mfma_f32_32x32x16_bf16 v[0:15], v[156:159], v[96:99], v[32:47]
    buffer_load_dwordx4 v[220:223], v254, s[12:15], s80 offen sc1
    s_add_u32 s80, s80, 8192
    v_exp_f32 v20, v20
    v_exp_f32 v21, v21
    v_exp_f32 v22, v22
    v_exp_f32 v23, v23
    v_mfma_f32_32x32x16_bf16 v[0:15], v[160:163], v[100:103], v[0:15]
    v_cvt_pk_bf16_f32 v122, v20, v21
    v_cvt_pk_bf16_f32 v123, v22, v23
    v_exp_f32 v24, v24
    v_mfma_f32_32x32x16_bf16 v[64:79], v[148:151], v[112:115], v[64:79]
    buffer_load_dwordx4 v[196:199], v204, s[12:15], s77 offen offset:2048
    v_exp_f32 v25, v25
    v_exp_f32 v26, v26
    v_exp_f32 v27, v27
    v_cvt_pk_bf16_f32 v124, v24, v25
    v_mfma_f32_32x32x16_bf16 v[64:79], v[152:155], v[116:119], v[64:79]
    buffer_load_dwordx4 v[200:203], v204, s[12:15], s77 offen offset:3072
    s_add_u32 s77, s77, 4096
    s_and_b32 s77, s77, 0x1ffff
    v_cvt_pk_bf16_f32 v125, v26, v27
    v_exp_f32 v28, v28
    v_exp_f32 v29, v29
    v_smfmac_f32_16x16x64_bf16 v[128:131], v[136:139], v[112:119], v205
    v_exp_f32 v30, v30
    v_exp_f32 v31, v31
    v_cvt_pk_bf16_f32 v126, v28, v29
    v_cvt_pk_bf16_f32 v127, v30, v31
    v_mfma_f32_32x32x16_bf16 v[16:31], v[156:159], v[104:107], v[48:63]
    v_exp_f32 v0, v0
    v_exp_f32 v1, v1
    v_exp_f32 v2, v2
    v_exp_f32 v3, v3
    v_mfma_f32_32x32x16_bf16 v[16:31], v[160:163], v[108:111], v[16:31]
    buffer_load_dwordx4 v[140:143], v204, s[12:15], s77 offen
    v_cvt_pk_bf16_f32 v112, v0, v1
    v_cvt_pk_bf16_f32 v113, v2, v3
    v_exp_f32 v4, v4
    v_exp_f32 v5, v5
    v_exp_f32 v6, v6
    v_mfma_f32_32x32x16_bf16 v[80:95], v[148:151], v[120:123], v[80:95]
    v_exp_f32 v7, v7
    v_cvt_pk_bf16_f32 v114, v4, v5
    v_cvt_pk_bf16_f32 v115, v6, v7
    v_exp_f32 v8, v8
    v_exp_f32 v9, v9
    v_mfma_f32_32x32x16_bf16 v[80:95], v[152:155], v[124:127], v[80:95]
    buffer_load_dwordx4 v[144:147], v204, s[12:15], s77 offen offset:1024
    v_exp_f32 v10, v10
    v_exp_f32 v11, v11
    v_cvt_pk_bf16_f32 v116, v8, v9
    v_cvt_pk_bf16_f32 v117, v10, v11
    v_exp_f32 v12, v12
    v_smfmac_f32_16x16x64_bf16 v[132:135], v[136:139], v[120:127], v205
    v_exp_f32 v13, v13
    v_exp_f32 v14, v14
    v_exp_f32 v15, v15
    v_cvt_pk_bf16_f32 v118, v12, v13
    v_cvt_pk_bf16_f32 v119, v14, v15
    s_waitcnt vmcnt(12)
    s_waitcnt vmcnt(10)
    v_mfma_f32_32x32x16_bf16 v[224:239], v[240:243], v[248:251], v[224:239]
    v_exp_f32 v16, v16
    v_exp_f32 v17, v17
    v_exp_f32 v18, v18
    v_mfma_f32_32x32x16_bf16 v[224:239], v[244:247], v[248:251], v[224:239]
    v_exp_f32 v19, v19
    v_cvt_pk_bf16_f32 v120, v16, v17
    v_cvt_pk_bf16_f32 v121, v18, v19
    v_mfma_f32_32x32x16_bf16 v[0:15], v[172:175], v[96:99], v[32:47]
    buffer_load_dwordx4 v[148:151], v204, s[12:15], s77 offen offset:2048
    v_exp_f32 v20, v20
    v_exp_f32 v21, v21
    v_exp_f32 v22, v22
    v_exp_f32 v23, v23
    v_mfma_f32_32x32x16_bf16 v[0:15], v[176:179], v[100:103], v[0:15]
    v_cvt_pk_bf16_f32 v122, v20, v21
    v_cvt_pk_bf16_f32 v123, v22, v23
    v_exp_f32 v24, v24
    v_mfma_f32_32x32x16_bf16 v[64:79], v[164:167], v[112:115], v[64:79]
    buffer_load_dwordx4 v[152:155], v204, s[12:15], s77 offen offset:3072
    s_add_u32 s77, s77, 4096
    s_and_b32 s77, s77, 0x1ffff
    v_exp_f32 v25, v25
    v_exp_f32 v26, v26
    v_exp_f32 v27, v27
    v_cvt_pk_bf16_f32 v124, v24, v25
    v_mfma_f32_32x32x16_bf16 v[64:79], v[168:171], v[116:119], v[64:79]
    v_cvt_pk_bf16_f32 v125, v26, v27
    v_exp_f32 v28, v28
    v_exp_f32 v29, v29
    v_smfmac_f32_16x16x64_bf16 v[128:131], v[136:139], v[112:119], v205
    v_exp_f32 v30, v30
    v_exp_f32 v31, v31
    v_cvt_pk_bf16_f32 v126, v28, v29
    v_cvt_pk_bf16_f32 v127, v30, v31
    v_mfma_f32_32x32x16_bf16 v[16:31], v[172:175], v[104:107], v[48:63]
    v_exp_f32 v0, v0
    v_exp_f32 v1, v1
    v_exp_f32 v2, v2
    v_exp_f32 v3, v3
    v_mfma_f32_32x32x16_bf16 v[16:31], v[176:179], v[108:111], v[16:31]
    buffer_load_dwordx4 v[156:159], v204, s[12:15], s77 offen
    v_cvt_pk_bf16_f32 v112, v0, v1
    v_cvt_pk_bf16_f32 v113, v2, v3
    v_exp_f32 v4, v4
    v_exp_f32 v5, v5
    v_exp_f32 v6, v6
    v_mfma_f32_32x32x16_bf16 v[80:95], v[164:167], v[120:123], v[80:95]
    v_exp_f32 v7, v7
    v_cvt_pk_bf16_f32 v114, v4, v5
    v_cvt_pk_bf16_f32 v115, v6, v7
    v_exp_f32 v8, v8
    v_exp_f32 v9, v9
    v_mfma_f32_32x32x16_bf16 v[80:95], v[168:171], v[124:127], v[80:95]
    buffer_load_dwordx4 v[160:163], v204, s[12:15], s77 offen offset:1024
    v_exp_f32 v10, v10
    v_exp_f32 v11, v11
    v_cvt_pk_bf16_f32 v116, v8, v9
    v_cvt_pk_bf16_f32 v117, v10, v11
    v_exp_f32 v12, v12
    v_smfmac_f32_16x16x64_bf16 v[132:135], v[136:139], v[120:127], v205
    v_exp_f32 v13, v13
    v_exp_f32 v14, v14
    v_exp_f32 v15, v15
    v_cvt_pk_bf16_f32 v118, v12, v13
    v_cvt_pk_bf16_f32 v119, v14, v15
    s_waitcnt vmcnt(10)
    s_waitcnt vmcnt(8)
    v_mfma_f32_32x32x16_bf16 v[224:239], v[216:219], v[248:251], v[224:239]
    v_exp_f32 v16, v16
    v_exp_f32 v17, v17
    v_exp_f32 v18, v18
    v_mfma_f32_32x32x16_bf16 v[224:239], v[220:223], v[248:251], v[224:239]
    v_exp_f32 v19, v19
    v_cvt_pk_bf16_f32 v120, v16, v17
    v_cvt_pk_bf16_f32 v121, v18, v19
    v_mfma_f32_32x32x16_bf16 v[0:15], v[188:191], v[96:99], v[32:47]
    buffer_load_dwordx4 v[164:167], v204, s[12:15], s77 offen offset:2048
    v_exp_f32 v20, v20
    v_exp_f32 v21, v21
    v_exp_f32 v22, v22
    v_exp_f32 v23, v23
    v_mfma_f32_32x32x16_bf16 v[0:15], v[192:195], v[100:103], v[0:15]
    v_cvt_pk_bf16_f32 v122, v20, v21
    v_cvt_pk_bf16_f32 v123, v22, v23
    v_exp_f32 v24, v24
    v_mfma_f32_32x32x16_bf16 v[64:79], v[180:183], v[112:115], v[64:79]
    buffer_load_dwordx4 v[168:171], v204, s[12:15], s77 offen offset:3072
    s_add_u32 s77, s77, 4096
    s_and_b32 s77, s77, 0x1ffff
    v_exp_f32 v25, v25
    v_exp_f32 v26, v26
    v_exp_f32 v27, v27
    v_cvt_pk_bf16_f32 v124, v24, v25
    v_mfma_f32_32x32x16_bf16 v[64:79], v[184:187], v[116:119], v[64:79]
    v_cvt_pk_bf16_f32 v125, v26, v27
    v_exp_f32 v28, v28
    v_exp_f32 v29, v29
    v_smfmac_f32_16x16x64_bf16 v[128:131], v[136:139], v[112:119], v205
    v_exp_f32 v30, v30
    v_exp_f32 v31, v31
    v_cvt_pk_bf16_f32 v126, v28, v29
    v_cvt_pk_bf16_f32 v127, v30, v31
    v_add_f32 v208, v208, v209
    v_add_f32 v208, v208, v210
    v_add_f32 v208, v208, v211
    v_add_f32 v208, v208, v212
    v_add_f32 v208, v208, v213
    v_add_f32 v208, v208, v214
    v_add_f32 v208, v208, v215
    v_cvt_pk_bf16_f32 v216, v224, v225
    v_cvt_pk_bf16_f32 v217, v226, v227
    v_cvt_pk_bf16_f32 v218, v228, v229
    v_cvt_pk_bf16_f32 v219, v230, v231
    v_cvt_pk_bf16_f32 v220, v232, v233
    v_cvt_pk_bf16_f32 v221, v234, v235
    v_cvt_pk_bf16_f32 v222, v236, v237
    v_cvt_pk_bf16_f32 v223, v238, v239
    s_lshl_b32 s64, s50, 1
    s_add_u32 s64, s64, s51
    s_lshl_b32 s64, s64, 13
    s_lshl_b32 s65, s49, 12
    s_add_u32 s64, s64, s65
    s_add_u32 s64, s64, 0x4000
    v_add_u32 v207, s64, v254
    v_mov_b32 v209, v208
    s_lshl_b32 s64, s50, 1
    s_add_u32 s64, s64, s49
    v_permlane32_swap_b32 v208, v209
    s_lshl_b32 s65, s64, 11
    s_add_u32 s65, s65, 0x25800
    v_add_u32 v206, s65, v254
    ds_read_b128 v[224:227], v207 offset:0
    ds_read_b128 v[228:231], v207 offset:1024
    ds_read_b128 v[232:235], v207 offset:2048
    ds_read_b128 v[236:239], v207 offset:3072
    v_add_f32 v208, v208, v209
    s_lshl_b32 s65, s64, 6
    s_add_u32 s65, s65, 0x27a40
    v_and_b32 v210, 31, v253
    v_lshlrev_b32 v209, 1, v210
    v_add_u32 v209, s65, v209
    v_cvt_pk_bf16_f32 v208, v208, v208
    s_lshl_b32 s65, s51, 4
    s_lshl_b32 s65, 0xffff, s65
    ds_write_b16 v209, v208
    s_mov_b32 exec_lo, s65
    s_mov_b32 exec_hi, s65
    ds_write_b128 v206, v[216:219]
    ds_write_b128 v206, v[220:223] offset:1024
    s_mov_b64 exec, 1
    v_mov_b32 v211, 0x27a10
    v_mov_b32 v212, 1
    ds_add_u32 v211, v212
    s_mov_b64 exec, -1
    v_mfma_f32_32x32x16_bf16 v[16:31], v[188:191], v[104:107], v[48:63]
    v_exp_f32 v0, v0
    v_exp_f32 v1, v1
    v_exp_f32 v2, v2
    v_exp_f32 v3, v3
    v_mfma_f32_32x32x16_bf16 v[16:31], v[192:195], v[108:111], v[16:31]
    buffer_load_dwordx4 v[172:175], v204, s[12:15], s77 offen
    v_cvt_pk_bf16_f32 v112, v0, v1
    v_cvt_pk_bf16_f32 v113, v2, v3
    v_exp_f32 v4, v4
    v_exp_f32 v5, v5
    v_exp_f32 v6, v6
    v_mfma_f32_32x32x16_bf16 v[80:95], v[180:183], v[120:123], v[80:95]
    v_exp_f32 v7, v7
    v_cvt_pk_bf16_f32 v114, v4, v5
    v_cvt_pk_bf16_f32 v115, v6, v7
    v_exp_f32 v8, v8
    v_exp_f32 v9, v9
    v_mfma_f32_32x32x16_bf16 v[80:95], v[184:187], v[124:127], v[80:95]
    buffer_load_dwordx4 v[176:179], v204, s[12:15], s77 offen offset:1024
    v_exp_f32 v10, v10
    v_exp_f32 v11, v11
    v_cvt_pk_bf16_f32 v116, v8, v9
    v_cvt_pk_bf16_f32 v117, v10, v11
    v_exp_f32 v12, v12
    v_smfmac_f32_16x16x64_bf16 v[132:135], v[136:139], v[120:127], v205
    v_exp_f32 v13, v13
    v_exp_f32 v14, v14
    v_exp_f32 v15, v15
    v_cvt_pk_bf16_f32 v118, v12, v13
    v_cvt_pk_bf16_f32 v119, v14, v15
    s_waitcnt vmcnt(8)
    v_mfma_f32_32x32x16_bf16 v[0:15], v[140:143], v[96:99], v[32:47]
    v_exp_f32 v16, v16
    v_exp_f32 v17, v17
    v_exp_f32 v18, v18
    v_exp_f32 v19, v19
    v_mfma_f32_32x32x16_bf16 v[0:15], v[144:147], v[100:103], v[0:15]
    buffer_load_dwordx4 v[180:183], v204, s[12:15], s77 offen offset:2048
    v_cvt_pk_bf16_f32 v120, v16, v17
    v_cvt_pk_bf16_f32 v121, v18, v19
    v_exp_f32 v20, v20
    v_exp_f32 v21, v21
    v_exp_f32 v22, v22
    v_mfma_f32_32x32x16_bf16 v[64:79], v[196:199], v[112:115], v[64:79]
    v_exp_f32 v23, v23
    v_cvt_pk_bf16_f32 v122, v20, v21
    v_cvt_pk_bf16_f32 v123, v22, v23
    v_exp_f32 v24, v24
    v_exp_f32 v25, v25
    v_mfma_f32_32x32x16_bf16 v[64:79], v[200:203], v[116:119], v[64:79]
    buffer_load_dwordx4 v[184:187], v204, s[12:15], s77 offen offset:3072
    s_add_u32 s77, s77, 4096
    s_and_b32 s77, s77, 0x1ffff
    v_exp_f32 v26, v26
    v_exp_f32 v27, v27
    v_cvt_pk_bf16_f32 v124, v24, v25
    v_cvt_pk_bf16_f32 v125, v26, v27
    v_exp_f32 v28, v28
    v_smfmac_f32_16x16x64_bf16 v[128:131], v[136:139], v[112:119], v205
    v_exp_f32 v29, v29
    v_exp_f32 v30, v30
    v_exp_f32 v31, v31
    v_cvt_pk_bf16_f32 v126, v28, v29
    v_cvt_pk_bf16_f32 v127, v30, v31
    s_lshl_b32 s64, s51, 6
    s_lshl_b32 s65, s49, 5
    s_add_u32 s64, s64, s65
    s_lshl_b32 s64, s64, 2
    s_add_u32 s64, s64, 0x25000
    v_and_b32 v207, 31, v253
    v_lshl_add_u32 v207, v207, 2, s64
    v_mov_b32 v20, 0x27a10
    ds_read_b32 v205, v207
    ds_read_b32 v16, v207 offset:512
    ds_read_b32 v17, v207 offset:1024
    ds_read_b32 v18, v207 offset:1536
    s_lshl_b32 s64, s50, 12
    s_add_u32 s64, s64, 0x25800
    v_add_u32 v206, s64, v254
    s_lshl_b32 s64, s50, 7
    s_add_u32 s64, s64, 0x27a40
    v_lshl_add_u32 v113, v255, 3, s64
    v_mov_b32 v114, 0x27b40
    v_lshrrev_b32 v115, 2, v253
    v_lshrrev_b32 v207, 4, v253
    v_xor_b32 v115, v115, v207
    v_and_b32 v115, 1, v115
    v_cmp_eq_u32 vcc, 0, v115
    s_nop 1
    v_cndmask_b32 v113, v114, v113, vcc
    s_mov_b32 s71, 0
L_mbs_51:
    ds_read_b32 v19, v20
    ds_read_b128 v[208:211], v206 offset:0
    ds_read_b128 v[212:215], v206 offset:1024
    ds_read_b128 v[216:219], v206 offset:2048
    ds_read_b128 v[220:223], v206 offset:3072
    ds_read_b64 v[240:241], v113 offset:0
    ds_read_b64 v[242:243], v113 offset:16
    ds_read_b64 v[244:245], v113 offset:32
    ds_read_b64 v[246:247], v113 offset:48
    ds_read_b64 v[248:249], v113 offset:64
    ds_read_b64 v[250:251], v113 offset:80
    ds_read_b64 v[116:117], v113 offset:96
    ds_read_b64 v[118:119], v113 offset:112
    s_waitcnt lgkmcnt(12)
    v_cmp_ne_u32 vcc, 8, v19
    s_cbranch_vccz L_mbok_52
    s_waitcnt lgkmcnt(0)
    s_add_u32 s71, s71, 1
    s_cmp_ge_u32 s71, 0x10000
    s_cbranch_scc1 L_mbok_52
    s_sleep 1
    s_branch L_mbs_51
L_mbok_52:
    v_add_f32 v205, v205, v16
    v_add_f32 v17, v17, v18
    v_add_f32 v205, v205, v17
    v_mul_f32 v205, s69, v205
    v_exp_f32 v205, -v205
    s_nop 0
    v_add_f32 v205, 1.0, v205
    v_rcp_f32 v205, v205
    s_waitcnt lgkmcnt(0)
    v_mfma_f32_32x32x16_bf16 v[16:31], v[208:211], v[224:227], 0
    v_mfma_f32_16x16x32_bf16 v[112:115], v[240:243], v[224:227], 0
    v_mfma_f32_32x32x16_bf16 v[16:31], v[212:215], v[228:231], v[16:31]
    v_mfma_f32_16x16x32_bf16 v[112:115], v[244:247], v[228:231], v[112:115]
    v_mfma_f32_32x32x16_bf16 v[16:31], v[216:219], v[232:235], v[16:31]
    v_mfma_f32_16x16x32_bf16 v[112:115], v[248:251], v[232:235], v[112:115]
    v_mfma_f32_32x32x16_bf16 v[16:31], v[220:223], v[236:239], v[16:31]
    v_mfma_f32_16x16x32_bf16 v[112:115], v[116:119], v[236:239], v[112:115]
    s_and_b32 s64, s48, 3
    s_lshl_b32 s65, s64, 4
    v_bfe_u32 v224, v253, 2, 3
    v_add_u32 v224, s65, v224
    v_lshlrev_b32 v224, 11, v224
    v_lshl_add_u32 v224, v255, 6, v224
    v_and_b32 v225, 3, v253
    v_lshl_add_u32 v224, v225, 4, v224
    s_lshl_b32 s65, s82, 7
    s_lshl_b32 s66, s49, 20
    s_add_u32 s66, s66, s65
    v_add_u32 v224, s66, v224
    v_bfe_u32 v226, v253, 2, 2
    v_lshlrev_b32 v226, 6, v226
    v_bfe_u32 v227, v253, 4, 1
    v_lshl_add_u32 v226, v227, 5, v226
    v_lshl_add_u32 v226, v225, 3, v226
    v_lshl_add_u32 v226, v255, 8, v226
    s_mul_i32 s66, s49, 8704
    v_add_u32 v226, s66, v226
    v_add_u32 v227, 0x10000, v226
    s_lshl_b32 s66, s81, 2
    s_add_u32 s66, s66, s64
    s_lshl_b32 s66, s66, 17
    s_lshl_b32 s67, s49, 15
    s_add_u32 s66, s66, s67
    s_add_u32 s66, s66, 0x800000
    v_add_u32 v225, s66, v254
    s_lshl_b32 s66, s48, 7
    v_add_u32 v228, s66, v253
    v_lshlrev_b32 v228, 11, v228
    v_add_u32 v228, s65, v228
    v_and_b32 v229, 15, v253
    v_lshlrev_b32 v229, 2, v229
    s_lshl_b32 s66, s81, 7
    v_add_u32 v229, s66, v229
    v_sub_f32 v230, 1.0, v205
    v_add_f32 v206, 0x358637bd, v112
    v_rcp_f32 v206, v206
    s_lshl_b32 s64, s53, 2
    s_lshl_b32 s65, s51, 1
    s_add_u32 s64, s64, s65
    s_add_u32 s64, s64, s49
    s_lshl_b32 s64, s64, 17
    s_lshl_b32 s65, s55, 11
    s_add_u32 s64, s64, s65
    s_add_u32 s80, s64, 0x800000
    v_mul_f32 v206, v206, v205
    v_mul_f32 v16, v16, v206
    v_mul_f32 v17, v17, v206
    v_mul_f32 v18, v18, v206
    v_mul_f32 v19, v19, v206
    v_mul_f32 v20, v20, v206
    v_mul_f32 v21, v21, v206
    v_mul_f32 v22, v22, v206
    v_mul_f32 v23, v23, v206
    v_mul_f32 v24, v24, v206
    v_mul_f32 v25, v25, v206
    v_mul_f32 v26, v26, v206
    v_mul_f32 v27, v27, v206
    v_mul_f32 v28, v28, v206
    v_mul_f32 v29, v29, v206
    v_mul_f32 v30, v30, v206
    v_mul_f32 v31, v31, v206
    v_cvt_pk_bf16_f32 v208, v16, v17
    v_cvt_pk_bf16_f32 v209, v18, v19
    v_cvt_pk_bf16_f32 v210, v20, v21
    v_cvt_pk_bf16_f32 v211, v22, v23
    v_cvt_pk_bf16_f32 v212, v24, v25
    v_cvt_pk_bf16_f32 v213, v26, v27
    v_cvt_pk_bf16_f32 v214, v28, v29
    v_cvt_pk_bf16_f32 v215, v30, v31
    buffer_store_dwordx4 v[208:211], v254, s[12:15], s80 offen sc1
    buffer_store_dwordx4 v[212:215], v254, s[12:15], s80 offen offset:1024 sc1
    s_add_u32 s80, s80, 65536
    v_and_b32 v205, 1, v253
    v_mul_u32_u24 v205, 0xaaaa, v205
    v_add_u32 v205, 0x4444, v205
    v_mfma_f32_32x32x16_bf16 v[16:31], v[140:143], v[104:107], v[48:63]
    v_exp_f32 v0, v0
    v_exp_f32 v1, v1
    v_exp_f32 v2, v2
    v_exp_f32 v3, v3
    v_mfma_f32_32x32x16_bf16 v[16:31], v[144:147], v[108:111], v[16:31]
    buffer_load_dwordx4 v[188:191], v204, s[12:15], s77 offen
    v_cvt_pk_bf16_f32 v112, v0, v1
    v_cvt_pk_bf16_f32 v113, v2, v3
    v_exp_f32 v4, v4
    v_exp_f32 v5, v5
    v_exp_f32 v6, v6
    v_mfma_f32_32x32x16_bf16 v[80:95], v[196:199], v[120:123], v[80:95]
    v_exp_f32 v7, v7
    v_cvt_pk_bf16_f32 v114, v4, v5
    v_cvt_pk_bf16_f32 v115, v6, v7
    v_exp_f32 v8, v8
    v_exp_f32 v9, v9
    v_mfma_f32_32x32x16_bf16 v[80:95], v[200:203], v[124:127], v[80:95]
    buffer_load_dwordx4 v[192:195], v204, s[12:15], s77 offen offset:1024
    v_exp_f32 v10, v10
    v_exp_f32 v11, v11
    v_cvt_pk_bf16_f32 v116, v8, v9
    v_cvt_pk_bf16_f32 v117, v10, v11
    v_exp_f32 v12, v12
    v_smfmac_f32_16x16x64_bf16 v[132:135], v[136:139], v[120:127], v205
    v_exp_f32 v13, v13
    v_exp_f32 v14, v14
    v_exp_f32 v15, v15
    v_cvt_pk_bf16_f32 v118, v12, v13
    v_cvt_pk_bf16_f32 v119, v14, v15
    s_waitcnt vmcnt(10)
    v_mfma_f32_32x32x16_bf16 v[0:15], v[156:159], v[96:99], v[32:47]
    buffer_load_dwordx4 v[196:199], v204, s[12:15], s77 offen offset:2048
    v_exp_f32 v16, v16
    v_exp_f32 v17, v17
    v_exp_f32 v18, v18
    v_exp_f32 v19, v19
    v_mfma_f32_32x32x16_bf16 v[0:15], v[160:163], v[100:103], v[0:15]
    buffer_load_dwordx4 v[200:203], v204, s[12:15], s77 offen offset:3072
    s_add_u32 s77, s77, 4096
    s_and_b32 s77, s77, 0x1ffff
    v_cvt_pk_bf16_f32 v120, v16, v17
    v_cvt_pk_bf16_f32 v121, v18, v19
    v_exp_f32 v20, v20
    v_exp_f32 v21, v21
    v_exp_f32 v22, v22
    s_add_u32 s65, s85, 0
    s_and_b32 s65, s65, 7
    s_lshl_b32 s65, s65, 17
    s_add_u32 m0, s56, 0x0
    s_add_u32 s65, s65, 0x0
    v_mfma_f32_32x32x16_bf16 v[64:79], v[148:151], v[112:115], v[64:79]
    buffer_load_dwordx4 v224, s[8:11], s65 offen lds
    v_exp_f32 v23, v23
    v_cvt_pk_bf16_f32 v122, v20, v21
    v_cvt_pk_bf16_f32 v123, v22, v23
    v_exp_f32 v24, v24
    v_exp_f32 v25, v25
    s_add_u32 s65, s85, 0
    s_and_b32 s65, s65, 7
    s_lshl_b32 s65, s65, 17
    s_add_u32 m0, s56, 0x400
    s_add_u32 s65, s65, 0x4000
    v_mfma_f32_32x32x16_bf16 v[64:79], v[152:155], v[116:119], v[64:79]
    buffer_load_dwordx4 v224, s[8:11], s65 offen lds
    v_exp_f32 v26, v26
    v_exp_f32 v27, v27
    v_cvt_pk_bf16_f32 v124, v24, v25
    v_cvt_pk_bf16_f32 v125, v26, v27
    v_exp_f32 v28, v28
    v_smfmac_f32_16x16x64_bf16 v[128:131], v[136:139], v[112:119], v205
    v_exp_f32 v29, v29
    v_exp_f32 v30, v30
    v_exp_f32 v31, v31
    v_cvt_pk_bf16_f32 v126, v28, v29
    v_cvt_pk_bf16_f32 v127, v30, v31
    v_mfma_f32_32x32x16_bf16 v[16:31], v[156:159], v[104:107], v[48:63]
    v_exp_f32 v0, v0
    v_exp_f32 v1, v1
    v_exp_f32 v2, v2
    v_exp_f32 v3, v3
    v_mfma_f32_32x32x16_bf16 v[16:31], v[160:163], v[108:111], v[16:31]
    buffer_load_dwordx4 v[140:143], v204, s[12:15], s77 offen
    v_cvt_pk_bf16_f32 v112, v0, v1
    v_cvt_pk_bf16_f32 v113, v2, v3
    v_exp_f32 v4, v4
    v_exp_f32 v5, v5
    v_exp_f32 v6, v6
    v_mfma_f32_32x32x16_bf16 v[80:95], v[148:151], v[120:123], v[80:95]
    v_exp_f32 v7, v7
    v_cvt_pk_bf16_f32 v114, v4, v5
    v_cvt_pk_bf16_f32 v115, v6, v7
    v_exp_f32 v8, v8
    v_exp_f32 v9, v9
    v_mfma_f32_32x32x16_bf16 v[80:95], v[152:155], v[124:127], v[80:95]
    buffer_load_dwordx4 v[144:147], v204, s[12:15], s77 offen offset:1024
    v_exp_f32 v10, v10
    v_exp_f32 v11, v11
    v_cvt_pk_bf16_f32 v116, v8, v9
    v_cvt_pk_bf16_f32 v117, v10, v11
    v_exp_f32 v12, v12
    v_smfmac_f32_16x16x64_bf16 v[132:135], v[136:139], v[120:127], v205
    v_exp_f32 v13, v13
    v_exp_f32 v14, v14
    v_exp_f32 v15, v15
    v_cvt_pk_bf16_f32 v118, v12, v13
    v_cvt_pk_bf16_f32 v119, v14, v15
    s_waitcnt vmcnt(12)
    v_mfma_f32_32x32x16_bf16 v[0:15], v[172:175], v[96:99], v[32:47]
    s_and_b32 s64, s2, 7
    s_lshr_b32 s65, s2, 3
    s_lshr_b32 s66, s64, 2
    s_lshl_b32 s66, s66, 3
    s_lshr_b32 s67, s65, 2
    s_add_u32 s66, s66, s67
    s_lshl_b32 s66, s66, 7
    s_and_b32 s65, s65, 3
    s_lshl_b32 s65, s65, 3
    s_add_u32 s65, s65, s48
    s_lshl_b32 s65, s65, 16
    s_add_u32 s66, s66, s65
    s_add_u32 s88, s38, s66
    s_addc_u32 s89, s39, 0
    v_exp_f32 v16, v16
    v_exp_f32 v17, v17
    v_exp_f32 v18, v18
    v_exp_f32 v19, v19
    v_mfma_f32_32x32x16_bf16 v[0:15], v[176:179], v[100:103], v[0:15]
    buffer_load_dwordx4 v[148:151], v204, s[12:15], s77 offen offset:2048
    v_cvt_pk_bf16_f32 v120, v16, v17
    v_cvt_pk_bf16_f32 v121, v18, v19
    v_exp_f32 v20, v20
    v_exp_f32 v21, v21
    v_exp_f32 v22, v22
    v_mfma_f32_32x32x16_bf16 v[64:79], v[164:167], v[112:115], v[64:79]
    buffer_load_dwordx4 v[152:155], v204, s[12:15], s77 offen offset:3072
    s_add_u32 s77, s77, 4096
    s_and_b32 s77, s77, 0x1ffff
    v_exp_f32 v23, v23
    v_cvt_pk_bf16_f32 v122, v20, v21
    v_cvt_pk_bf16_f32 v123, v22, v23
    v_exp_f32 v24, v24
    v_exp_f32 v25, v25
    s_add_u32 s65, s85, 1
    s_and_b32 s65, s65, 7
    s_lshl_b32 s65, s65, 17
    s_add_u32 m0, s56, 0x4000
    s_add_u32 s65, s65, 0x0
    v_mfma_f32_32x32x16_bf16 v[64:79], v[168:171], v[116:119], v[64:79]
    buffer_load_dwordx4 v224, s[8:11], s65 offen lds
    v_exp_f32 v26, v26
    v_exp_f32 v27, v27
    v_cvt_pk_bf16_f32 v124, v24, v25
    v_cvt_pk_bf16_f32 v125, v26, v27
    v_exp_f32 v28, v28
    s_add_u32 s65, s85, 1
    s_and_b32 s65, s65, 7
    s_lshl_b32 s65, s65, 17
    s_add_u32 m0, s56, 0x4400
    s_add_u32 s65, s65, 0x4000
    v_smfmac_f32_16x16x64_bf16 v[128:131], v[136:139], v[112:119], v205
    buffer_load_dwordx4 v224, s[8:11], s65 offen lds
    v_exp_f32 v29, v29
    v_exp_f32 v30, v30
    v_exp_f32 v31, v31
    v_cvt_pk_bf16_f32 v126, v28, v29
    v_cvt_pk_bf16_f32 v127, v30, v31
    s_waitcnt vmcnt(12)
    s_mov_b64 exec, 1
    v_mov_b32 v233, 0x27a08
    v_mov_b32 v234, 1
    ds_add_rtn_u32 v234, v233, v234
    s_waitcnt lgkmcnt(0)
    v_cmp_ne_u32 vcc, 7, v234
    s_cbranch_vccnz L_noflag_53
    s_mov_b32 s64, s83
    v_mov_b32 v234, 1
    v_mov_b32 v233, 0
    buffer_store_dword v234, v233, s[12:15], s64 offen sc1
L_noflag_53:
    s_mov_b64 exec, -1
    s_cmp_eq_u32 s49, 0
    s_cbranch_scc0 L_pr_54
    s_setprio 0
L_pr_54:
    v_mfma_f32_32x32x16_bf16 v[16:31], v[172:175], v[104:107], v[48:63]
    v_exp_f32 v0, v0
    v_exp_f32 v1, v1
    v_exp_f32 v2, v2
    v_exp_f32 v3, v3
    v_mfma_f32_32x32x16_bf16 v[16:31], v[176:179], v[108:111], v[16:31]
    buffer_load_dwordx4 v[156:159], v204, s[12:15], s77 offen
    v_cvt_pk_bf16_f32 v112, v0, v1
    v_cvt_pk_bf16_f32 v113, v2, v3
    v_exp_f32 v4, v4
    v_exp_f32 v5, v5
    v_exp_f32 v6, v6
    v_mfma_f32_32x32x16_bf16 v[80:95], v[164:167], v[120:123], v[80:95]
    v_exp_f32 v7, v7
    v_cvt_pk_bf16_f32 v114, v4, v5
    v_cvt_pk_bf16_f32 v115, v6, v7
    v_exp_f32 v8, v8
    v_exp_f32 v9, v9
    v_mfma_f32_32x32x16_bf16 v[80:95], v[168:171], v[124:127], v[80:95]
    buffer_load_dwordx4 v[160:163], v204, s[12:15], s77 offen offset:1024
    v_exp_f32 v10, v10
    v_exp_f32 v11, v11
    v_cvt_pk_bf16_f32 v116, v8, v9
    v_cvt_pk_bf16_f32 v117, v10, v11
    v_exp_f32 v12, v12
    v_smfmac_f32_16x16x64_bf16 v[132:135], v[136:139], v[120:127], v205
    v_exp_f32 v13, v13
    v_exp_f32 v14, v14
    v_exp_f32 v15, v15
    v_cvt_pk_bf16_f32 v118, v12, v13
    v_cvt_pk_bf16_f32 v119, v14, v15
    s_waitcnt vmcnt(12)
    v_mfma_f32_32x32x16_bf16 v[0:15], v[188:191], v[96:99], v[32:47]
    buffer_load_dwordx4 v[164:167], v204, s[12:15], s77 offen offset:2048
    v_exp_f32 v16, v16
    v_exp_f32 v17, v17
    v_exp_f32 v18, v18
    v_exp_f32 v19, v19
    v_mfma_f32_32x32x16_bf16 v[0:15], v[192:195], v[100:103], v[0:15]
    buffer_load_dwordx4 v[168:171], v204, s[12:15], s77 offen offset:3072
    s_add_u32 s77, s77, 4096
    s_and_b32 s77, s77, 0x1ffff
    v_cvt_pk_bf16_f32 v120, v16, v17
    v_cvt_pk_bf16_f32 v121, v18, v19
    v_exp_f32 v20, v20
    v_exp_f32 v21, v21
    v_exp_f32 v22, v22
    s_add_u32 s65, s85, 2
    s_and_b32 s65, s65, 7
    s_lshl_b32 s65, s65, 17
    s_add_u32 m0, s56, 0x8000
    s_add_u32 s65, s65, 0x0
    v_mfma_f32_32x32x16_bf16 v[64:79], v[180:183], v[112:115], v[64:79]
    buffer_load_dwordx4 v224, s[8:11], s65 offen lds
    v_exp_f32 v23, v23
    v_cvt_pk_bf16_f32 v122, v20, v21
    v_cvt_pk_bf16_f32 v123, v22, v23
    v_exp_f32 v24, v24
    v_exp_f32 v25, v25
    s_add_u32 s65, s85, 2
    s_and_b32 s65, s65, 7
    s_lshl_b32 s65, s65, 17
    s_add_u32 m0, s56, 0x8400
    s_add_u32 s65, s65, 0x4000
    v_mfma_f32_32x32x16_bf16 v[64:79], v[184:187], v[116:119], v[64:79]
    buffer_load_dwordx4 v224, s[8:11], s65 offen lds
    v_exp_f32 v26, v26
    v_exp_f32 v27, v27
    v_cvt_pk_bf16_f32 v124, v24, v25
    v_cvt_pk_bf16_f32 v125, v26, v27
    v_exp_f32 v28, v28
    v_smfmac_f32_16x16x64_bf16 v[128:131], v[136:139], v[112:119], v205
    v_exp_f32 v29, v29
    v_exp_f32 v30, v30
    v_exp_f32 v31, v31
    v_cvt_pk_bf16_f32 v126, v28, v29
    v_cvt_pk_bf16_f32 v127, v30, v31
    s_cmp_eq_u32 s49, 0
    s_cbranch_scc0 L_pr_55
    s_setprio 2
L_pr_55:
    v_mfma_f32_32x32x16_bf16 v[16:31], v[188:191], v[104:107], v[48:63]
    v_exp_f32 v0, v0
    v_exp_f32 v1, v1
    v_exp_f32 v2, v2
    v_exp_f32 v3, v3
    v_mfma_f32_32x32x16_bf16 v[16:31], v[192:195], v[108:111], v[16:31]
    buffer_load_dwordx4 v[172:175], v204, s[12:15], s77 offen
    v_cvt_pk_bf16_f32 v112, v0, v1
    v_cvt_pk_bf16_f32 v113, v2, v3
    v_exp_f32 v4, v4
    v_exp_f32 v5, v5
    v_exp_f32 v6, v6
    v_mfma_f32_32x32x16_bf16 v[80:95], v[180:183], v[120:123], v[80:95]
    v_exp_f32 v7, v7
    v_cvt_pk_bf16_f32 v114, v4, v5
    v_cvt_pk_bf16_f32 v115, v6, v7
    v_exp_f32 v8, v8
    v_exp_f32 v9, v9
    v_mfma_f32_32x32x16_bf16 v[80:95], v[184:187], v[124:127], v[80:95]
    buffer_load_dwordx4 v[176:179], v204, s[12:15], s77 offen offset:1024
    v_exp_f32 v10, v10
    v_exp_f32 v11, v11
    v_cvt_pk_bf16_f32 v116, v8, v9
    v_cvt_pk_bf16_f32 v117, v10, v11
    v_exp_f32 v12, v12
    v_smfmac_f32_16x16x64_bf16 v[132:135], v[136:139], v[120:127], v205
    v_exp_f32 v13, v13
    v_exp_f32 v14, v14
    v_exp_f32 v15, v15
    v_cvt_pk_bf16_f32 v118, v12, v13
    v_cvt_pk_bf16_f32 v119, v14, v15
    s_waitcnt vmcnt(12)
    v_mfma_f32_32x32x16_bf16 v[0:15], v[140:143], v[96:99], v[32:47]
    buffer_load_dwordx4 v[180:183], v204, s[12:15], s77 offen offset:2048
    v_exp_f32 v16, v16
    v_exp_f32 v17, v17
    v_exp_f32 v18, v18
    v_exp_f32 v19, v19
    v_mfma_f32_32x32x16_bf16 v[0:15], v[144:147], v[100:103], v[0:15]
    buffer_load_dwordx4 v[184:187], v204, s[12:15], s77 offen offset:3072
    s_add_u32 s77, s77, 4096
    s_and_b32 s77, s77, 0x1ffff
    v_cvt_pk_bf16_f32 v120, v16, v17
    v_cvt_pk_bf16_f32 v121, v18, v19
    v_exp_f32 v20, v20
    v_exp_f32 v21, v21
    v_exp_f32 v22, v22
    s_add_u32 s65, s85, 3
    s_and_b32 s65, s65, 7
    s_lshl_b32 s65, s65, 17
    s_add_u32 m0, s56, 0xc000
    s_add_u32 s65, s65, 0x0
    v_mfma_f32_32x32x16_bf16 v[64:79], v[196:199], v[112:115], v[64:79]
    buffer_load_dwordx4 v224, s[8:11], s65 offen lds
    v_exp_f32 v23, v23
    v_cvt_pk_bf16_f32 v122, v20, v21
    v_cvt_pk_bf16_f32 v123, v22, v23
    v_exp_f32 v24, v24
    v_exp_f32 v25, v25
    s_add_u32 s65, s85, 3
    s_and_b32 s65, s65, 7
    s_lshl_b32 s65, s65, 17
    s_add_u32 m0, s56, 0xc400
    s_add_u32 s65, s65, 0x4000
    v_mfma_f32_32x32x16_bf16 v[64:79], v[200:203], v[116:119], v[64:79]
    buffer_load_dwordx4 v224, s[8:11], s65 offen lds
    v_exp_f32 v26, v26
    v_exp_f32 v27, v27
    v_cvt_pk_bf16_f32 v124, v24, v25
    v_cvt_pk_bf16_f32 v125, v26, v27
    v_exp_f32 v28, v28
    v_smfmac_f32_16x16x64_bf16 v[128:131], v[136:139], v[112:119], v205
    v_exp_f32 v29, v29
    v_exp_f32 v30, v30
    v_exp_f32 v31, v31
    v_cvt_pk_bf16_f32 v126, v28, v29
    v_cvt_pk_bf16_f32 v127, v30, v31
    v_mfma_f32_32x32x16_bf16 v[16:31], v[140:143], v[104:107], v[48:63]
    v_exp_f32 v0, v0
    v_exp_f32 v1, v1
    v_exp_f32 v2, v2
    v_exp_f32 v3, v3
    v_mfma_f32_32x32x16_bf16 v[16:31], v[144:147], v[108:111], v[16:31]
    buffer_load_dwordx4 v[188:191], v204, s[12:15], s77 offen
    v_cvt_pk_bf16_f32 v112, v0, v1
    v_cvt_pk_bf16_f32 v113, v2, v3
    v_exp_f32 v4, v4
    v_exp_f32 v5, v5
    v_exp_f32 v6, v6
    v_mfma_f32_32x32x16_bf16 v[80:95], v[196:199], v[120:123], v[80:95]
    v_exp_f32 v7, v7
    v_cvt_pk_bf16_f32 v114, v4, v5
    v_cvt_pk_bf16_f32 v115, v6, v7
    v_exp_f32 v8, v8
    v_exp_f32 v9, v9
    v_mfma_f32_32x32x16_bf16 v[80:95], v[200:203], v[124:127], v[80:95]
    buffer_load_dwordx4 v[192:195], v204, s[12:15], s77 offen offset:1024
    v_exp_f32 v10, v10
    v_exp_f32 v11, v11
    v_cvt_pk_bf16_f32 v116, v8, v9
    v_cvt_pk_bf16_f32 v117, v10, v11
    v_exp_f32 v12, v12
    v_smfmac_f32_16x16x64_bf16 v[132:135], v[136:139], v[120:127], v205
    v_exp_f32 v13, v13
    v_exp_f32 v14, v14
    v_exp_f32 v15, v15
    v_cvt_pk_bf16_f32 v118, v12, v13
    v_cvt_pk_bf16_f32 v119, v14, v15
    s_waitcnt vmcnt(12)
    v_mfma_f32_32x32x16_bf16 v[0:15], v[156:159], v[96:99], v[32:47]
    buffer_load_dwordx4 v[196:199], v204, s[12:15], s77 offen offset:2048
    v_exp_f32 v16, v16
    v_exp_f32 v17, v17
    v_exp_f32 v18, v18
    v_exp_f32 v19, v19
    v_mfma_f32_32x32x16_bf16 v[0:15], v[160:163], v[100:103], v[0:15]
    buffer_load_dwordx4 v[200:203], v204, s[12:15], s77 offen offset:3072
    s_add_u32 s77, s77, 4096
    s_and_b32 s77, s77, 0x1ffff
    v_cvt_pk_bf16_f32 v120, v16, v17
    v_cvt_pk_bf16_f32 v121, v18, v19
    v_exp_f32 v20, v20
    v_exp_f32 v21, v21
    v_exp_f32 v22, v22
    s_add_u32 s65, s85, 4
    s_and_b32 s65, s65, 7
    s_lshl_b32 s65, s65, 17
    s_add_u32 m0, s56, 0x10000
    s_add_u32 s65, s65, 0x0
    v_mfma_f32_32x32x16_bf16 v[64:79], v[148:151], v[112:115], v[64:79]
    buffer_load_dwordx4 v224, s[8:11], s65 offen lds
    v_exp_f32 v23, v23
    v_cvt_pk_bf16_f32 v122, v20, v21
    v_cvt_pk_bf16_f32 v123, v22, v23
    v_exp_f32 v24, v24
    v_exp_f32 v25, v25
    s_add_u32 s65, s85, 4
    s_and_b32 s65, s65, 7
    s_lshl_b32 s65, s65, 17
    s_add_u32 m0, s56, 0x10400
    s_add_u32 s65, s65, 0x4000
    v_mfma_f32_32x32x16_bf16 v[64:79], v[152:155], v[116:119], v[64:79]
    buffer_load_dwordx4 v224, s[8:11], s65 offen lds
    v_exp_f32 v26, v26
    v_exp_f32 v27, v27
    v_cvt_pk_bf16_f32 v124, v24, v25
    v_cvt_pk_bf16_f32 v125, v26, v27
    v_exp_f32 v28, v28
    v_smfmac_f32_16x16x64_bf16 v[128:131], v[136:139], v[112:119], v205
    v_exp_f32 v29, v29
    v_exp_f32 v30, v30
    v_exp_f32 v31, v31
    v_cvt_pk_bf16_f32 v126, v28, v29
    v_cvt_pk_bf16_f32 v127, v30, v31
    s_cmp_eq_u32 s49, 0
    s_cbranch_scc0 L_pr_56
    s_setprio 0
L_pr_56:
    v_mfma_f32_32x32x16_bf16 v[16:31], v[156:159], v[104:107], v[48:63]
    v_exp_f32 v0, v0
    v_exp_f32 v1, v1
    v_exp_f32 v2, v2
    v_exp_f32 v3, v3
    v_mfma_f32_32x32x16_bf16 v[16:31], v[160:163], v[108:111], v[16:31]
    buffer_load_dwordx4 v[140:143], v204, s[12:15], s77 offen
    v_cvt_pk_bf16_f32 v112, v0, v1
    v_cvt_pk_bf16_f32 v113, v2, v3
    v_exp_f32 v4, v4
    v_exp_f32 v5, v5
    v_exp_f32 v6, v6
    v_mfma_f32_32x32x16_bf16 v[80:95], v[148:151], v[120:123], v[80:95]
    v_exp_f32 v7, v7
    v_cvt_pk_bf16_f32 v114, v4, v5
    v_cvt_pk_bf16_f32 v115, v6, v7
    v_exp_f32 v8, v8
    v_exp_f32 v9, v9
    v_mfma_f32_32x32x16_bf16 v[80:95], v[152:155], v[124:127], v[80:95]
    buffer_load_dwordx4 v[144:147], v204, s[12:15], s77 offen offset:1024
    v_exp_f32 v10, v10
    v_exp_f32 v11, v11
    v_cvt_pk_bf16_f32 v116, v8, v9
    v_cvt_pk_bf16_f32 v117, v10, v11
    v_exp_f32 v12, v12
    v_smfmac_f32_16x16x64_bf16 v[132:135], v[136:139], v[120:127], v205
    v_exp_f32 v13, v13
    v_exp_f32 v14, v14
    v_exp_f32 v15, v15
    v_cvt_pk_bf16_f32 v118, v12, v13
    v_cvt_pk_bf16_f32 v119, v14, v15
    s_waitcnt vmcnt(12)
    v_mfma_f32_32x32x16_bf16 v[0:15], v[172:175], v[96:99], v[32:47]
    buffer_load_dwordx4 v[148:151], v204, s[12:15], s77 offen offset:2048
    v_exp_f32 v16, v16
    v_exp_f32 v17, v17
    v_exp_f32 v18, v18
    v_exp_f32 v19, v19
    v_mfma_f32_32x32x16_bf16 v[0:15], v[176:179], v[100:103], v[0:15]
    buffer_load_dwordx4 v[152:155], v204, s[12:15], s77 offen offset:3072
    s_add_u32 s77, s77, 4096
    s_and_b32 s77, s77, 0x1ffff
    v_cvt_pk_bf16_f32 v120, v16, v17
    v_cvt_pk_bf16_f32 v121, v18, v19
    v_exp_f32 v20, v20
    v_exp_f32 v21, v21
    v_exp_f32 v22, v22
    s_add_u32 s65, s85, 5
    s_and_b32 s65, s65, 7
    s_lshl_b32 s65, s65, 17
    s_add_u32 m0, s56, 0x14000
    s_add_u32 s65, s65, 0x0
    v_mfma_f32_32x32x16_bf16 v[64:79], v[164:167], v[112:115], v[64:79]
    buffer_load_dwordx4 v224, s[8:11], s65 offen lds
    v_exp_f32 v23, v23
    v_cvt_pk_bf16_f32 v122, v20, v21
    v_cvt_pk_bf16_f32 v123, v22, v23
    v_exp_f32 v24, v24
    v_exp_f32 v25, v25
    s_add_u32 s65, s85, 5
    s_and_b32 s65, s65, 7
    s_lshl_b32 s65, s65, 17
    s_add_u32 m0, s56, 0x14400
    s_add_u32 s65, s65, 0x4000
    v_mfma_f32_32x32x16_bf16 v[64:79], v[168:171], v[116:119], v[64:79]
    buffer_load_dwordx4 v224, s[8:11], s65 offen lds
    v_exp_f32 v26, v26
    v_exp_f32 v27, v27
    v_cvt_pk_bf16_f32 v124, v24, v25
    v_cvt_pk_bf16_f32 v125, v26, v27
    v_exp_f32 v28, v28
    v_smfmac_f32_16x16x64_bf16 v[128:131], v[136:139], v[112:119], v205
    v_exp_f32 v29, v29
    v_exp_f32 v30, v30
    v_exp_f32 v31, v31
    v_cvt_pk_bf16_f32 v126, v28, v29
    v_cvt_pk_bf16_f32 v127, v30, v31
    s_cmp_eq_u32 s49, 0
    s_cbranch_scc0 L_pr_57
    s_setprio 2
L_pr_57:
    v_mfma_f32_32x32x16_bf16 v[16:31], v[172:175], v[104:107], v[48:63]
    v_exp_f32 v0, v0
    v_exp_f32 v1, v1
    v_exp_f32 v2, v2
    v_exp_f32 v3, v3
    v_mfma_f32_32x32x16_bf16 v[16:31], v[176:179], v[108:111], v[16:31]
    buffer_load_dwordx4 v[156:159], v204, s[12:15], s77 offen
    v_cvt_pk_bf16_f32 v112, v0, v1
    v_cvt_pk_bf16_f32 v113, v2, v3
    v_exp_f32 v4, v4
    v_exp_f32 v5, v5
    v_exp_f32 v6, v6
    v_mfma_f32_32x32x16_bf16 v[80:95], v[164:167], v[120:123], v[80:95]
    v_exp_f32 v7, v7
    v_cvt_pk_bf16_f32 v114, v4, v5
    v_cvt_pk_bf16_f32 v115, v6, v7
    v_exp_f32 v8, v8
    v_exp_f32 v9, v9
    v_mfma_f32_32x32x16_bf16 v[80:95], v[168:171], v[124:127], v[80:95]
    buffer_load_dwordx4 v[160:163], v204, s[12:15], s77 offen offset:1024
    v_exp_f32 v10, v10
    v_exp_f32 v11, v11
    v_cvt_pk_bf16_f32 v116, v8, v9
    v_cvt_pk_bf16_f32 v117, v10, v11
    v_exp_f32 v12, v12
    v_smfmac_f32_16x16x64_bf16 v[132:135], v[136:139], v[120:127], v205
    v_exp_f32 v13, v13
    v_exp_f32 v14, v14
    v_exp_f32 v15, v15
    v_cvt_pk_bf16_f32 v118, v12, v13
    v_cvt_pk_bf16_f32 v119, v14, v15
    s_waitcnt vmcnt(12)
    v_mfma_f32_32x32x16_bf16 v[0:15], v[188:191], v[96:99], v[32:47]
    buffer_load_dwordx4 v[164:167], v204, s[12:15], s77 offen offset:2048
    v_exp_f32 v16, v16
    v_exp_f32 v17, v17
    v_exp_f32 v18, v18
    v_exp_f32 v19, v19
    v_mfma_f32_32x32x16_bf16 v[0:15], v[192:195], v[100:103], v[0:15]
    buffer_load_dwordx4 v[168:171], v204, s[12:15], s77 offen offset:3072
    s_add_u32 s77, s77, 4096
    s_and_b32 s77, s77, 0x1ffff
    v_cvt_pk_bf16_f32 v120, v16, v17
    v_cvt_pk_bf16_f32 v121, v18, v19
    v_exp_f32 v20, v20
    v_exp_f32 v21, v21
    v_exp_f32 v22, v22
    s_add_u32 s65, s85, 6
    s_and_b32 s65, s65, 7
    s_lshl_b32 s65, s65, 17
    s_add_u32 m0, s56, 0x18000
    s_add_u32 s65, s65, 0x0
    v_mfma_f32_32x32x16_bf16 v[64:79], v[180:183], v[112:115], v[64:79]
    buffer_load_dwordx4 v224, s[8:11], s65 offen lds
    v_exp_f32 v23, v23
    v_cvt_pk_bf16_f32 v122, v20, v21
    v_cvt_pk_bf16_f32 v123, v22, v23
    v_exp_f32 v24, v24
    v_exp_f32 v25, v25
    s_add_u32 s65, s85, 6
    s_and_b32 s65, s65, 7
    s_lshl_b32 s65, s65, 17
    s_add_u32 m0, s56, 0x18400
    s_add_u32 s65, s65, 0x4000
    v_mfma_f32_32x32x16_bf16 v[64:79], v[184:187], v[116:119], v[64:79]
    buffer_load_dwordx4 v224, s[8:11], s65 offen lds
    v_exp_f32 v26, v26
    v_exp_f32 v27, v27
    v_cvt_pk_bf16_f32 v124, v24, v25
    v_cvt_pk_bf16_f32 v125, v26, v27
    v_exp_f32 v28, v28
    v_smfmac_f32_16x16x64_bf16 v[128:131], v[136:139], v[112:119], v205
    v_exp_f32 v29, v29
    v_exp_f32 v30, v30
    v_exp_f32 v31, v31
    v_cvt_pk_bf16_f32 v126, v28, v29
    v_cvt_pk_bf16_f32 v127, v30, v31
    v_mfma_f32_32x32x16_bf16 v[16:31], v[188:191], v[104:107], v[48:63]
    v_exp_f32 v0, v0
    v_exp_f32 v1, v1
    v_exp_f32 v2, v2
    v_exp_f32 v3, v3
    v_mfma_f32_32x32x16_bf16 v[16:31], v[192:195], v[108:111], v[16:31]
    buffer_load_dwordx4 v[172:175], v204, s[12:15], s77 offen
    v_cvt_pk_bf16_f32 v112, v0, v1
    v_cvt_pk_bf16_f32 v113, v2, v3
    v_exp_f32 v4, v4
    v_exp_f32 v5, v5
    v_exp_f32 v6, v6
    v_mfma_f32_32x32x16_bf16 v[80:95], v[180:183], v[120:123], v[80:95]
    v_exp_f32 v7, v7
    v_cvt_pk_bf16_f32 v114, v4, v5
    v_cvt_pk_bf16_f32 v115, v6, v7
    v_exp_f32 v8, v8
    v_exp_f32 v9, v9
    v_mfma_f32_32x32x16_bf16 v[80:95], v[184:187], v[124:127], v[80:95]
    buffer_load_dwordx4 v[176:179], v204, s[12:15], s77 offen offset:1024
    v_exp_f32 v10, v10
    v_exp_f32 v11, v11
    v_cvt_pk_bf16_f32 v116, v8, v9
    v_cvt_pk_bf16_f32 v117, v10, v11
    v_exp_f32 v12, v12
    v_smfmac_f32_16x16x64_bf16 v[132:135], v[136:139], v[120:127], v205
    v_exp_f32 v13, v13
    v_exp_f32 v14, v14
    v_exp_f32 v15, v15
    v_cvt_pk_bf16_f32 v118, v12, v13
    v_cvt_pk_bf16_f32 v119, v14, v15
    s_waitcnt vmcnt(12)
    v_mfma_f32_32x32x16_bf16 v[0:15], v[140:143], v[96:99], v[32:47]
    buffer_load_dwordx4 v[180:183], v204, s[12:15], s77 offen offset:2048
    v_exp_f32 v16, v16
    v_exp_f32 v17, v17
    v_exp_f32 v18, v18
    v_exp_f32 v19, v19
    v_mfma_f32_32x32x16_bf16 v[0:15], v[144:147], v[100:103], v[0:15]
    buffer_load_dwordx4 v[184:187], v204, s[12:15], s77 offen offset:3072
    s_add_u32 s77, s77, 4096
    s_and_b32 s77, s77, 0x1ffff
    v_cvt_pk_bf16_f32 v120, v16, v17
    v_cvt_pk_bf16_f32 v121, v18, v19
    v_exp_f32 v20, v20
    v_exp_f32 v21, v21
    v_exp_f32 v22, v22
    s_add_u32 s65, s85, 7
    s_and_b32 s65, s65, 7
    s_lshl_b32 s65, s65, 17
    s_add_u32 m0, s56, 0x1c000
    s_add_u32 s65, s65, 0x0
    v_mfma_f32_32x32x16_bf16 v[64:79], v[196:199], v[112:115], v[64:79]
    buffer_load_dwordx4 v224, s[8:11], s65 offen lds
    v_exp_f32 v23, v23
    v_cvt_pk_bf16_f32 v122, v20, v21
    v_cvt_pk_bf16_f32 v123, v22, v23
    v_exp_f32 v24, v24
    v_exp_f32 v25, v25
    s_add_u32 s65, s85, 7
    s_and_b32 s65, s65, 7
    s_lshl_b32 s65, s65, 17
    s_add_u32 m0, s56, 0x1c400
    s_add_u32 s65, s65, 0x4000
    v_mfma_f32_32x32x16_bf16 v[64:79], v[200:203], v[116:119], v[64:79]
    buffer_load_dwordx4 v224, s[8:11], s65 offen lds
    v_exp_f32 v26, v26
    v_exp_f32 v27, v27
    v_cvt_pk_bf16_f32 v124, v24, v25
    v_cvt_pk_bf16_f32 v125, v26, v27
    v_exp_f32 v28, v28
    v_smfmac_f32_16x16x64_bf16 v[128:131], v[136:139], v[112:119], v205
    v_exp_f32 v29, v29
    v_exp_f32 v30, v30
    v_exp_f32 v31, v31
    v_cvt_pk_bf16_f32 v126, v28, v29
    v_cvt_pk_bf16_f32 v127, v30, v31
    s_cmp_eq_u32 s49, 0
    s_cbranch_scc0 L_pr_58
    s_setprio 0
L_pr_58:
    v_mfma_f32_32x32x16_bf16 v[16:31], v[140:143], v[104:107], v[48:63]
    v_exp_f32 v0, v0
    v_exp_f32 v1, v1
    v_exp_f32 v2, v2
    v_exp_f32 v3, v3
    v_mfma_f32_32x32x16_bf16 v[16:31], v[144:147], v[108:111], v[16:31]
    buffer_load_dwordx4 v[188:191], v204, s[12:15], s77 offen
    v_cvt_pk_bf16_f32 v112, v0, v1
    v_cvt_pk_bf16_f32 v113, v2, v3
    v_exp_f32 v4, v4
    v_exp_f32 v5, v5
    v_exp_f32 v6, v6
    v_mfma_f32_32x32x16_bf16 v[80:95], v[196:199], v[120:123], v[80:95]
    v_exp_f32 v7, v7
    v_cvt_pk_bf16_f32 v114, v4, v5
    v_cvt_pk_bf16_f32 v115, v6, v7
    v_exp_f32 v8, v8
    v_exp_f32 v9, v9
    v_mfma_f32_32x32x16_bf16 v[80:95], v[200:203], v[124:127], v[80:95]
    buffer_load_dwordx4 v[192:195], v204, s[12:15], s77 offen offset:1024
    v_exp_f32 v10, v10
    v_exp_f32 v11, v11
    v_cvt_pk_bf16_f32 v116, v8, v9
    v_cvt_pk_bf16_f32 v117, v10, v11
    v_exp_f32 v12, v12
    v_smfmac_f32_16x16x64_bf16 v[132:135], v[136:139], v[120:127], v205
    v_exp_f32 v13, v13
    v_exp_f32 v14, v14
    v_exp_f32 v15, v15
    v_cvt_pk_bf16_f32 v118, v12, v13
    v_cvt_pk_bf16_f32 v119, v14, v15
    s_waitcnt vmcnt(12)
    v_mfma_f32_32x32x16_bf16 v[0:15], v[156:159], v[96:99], v[32:47]
    v_exp_f32 v16, v16
    v_exp_f32 v17, v17
    v_exp_f32 v18, v18
    v_exp_f32 v19, v19
    v_mfma_f32_32x32x16_bf16 v[0:15], v[160:163], v[100:103], v[0:15]
    buffer_load_dwordx4 v[196:199], v204, s[12:15], s77 offen offset:2048
    v_cvt_pk_bf16_f32 v120, v16, v17
    v_cvt_pk_bf16_f32 v121, v18, v19
    v_exp_f32 v20, v20
    v_exp_f32 v21, v21
    v_exp_f32 v22, v22
    v_mfma_f32_32x32x16_bf16 v[64:79], v[148:151], v[112:115], v[64:79]
    v_exp_f32 v23, v23
    v_cvt_pk_bf16_f32 v122, v20, v21
    v_cvt_pk_bf16_f32 v123, v22, v23
    v_exp_f32 v24, v24
    v_exp_f32 v25, v25
    v_mfma_f32_32x32x16_bf16 v[64:79], v[152:155], v[116:119], v[64:79]
    buffer_load_dwordx4 v[200:203], v204, s[12:15], s77 offen offset:3072
    s_add_u32 s77, s77, 4096
    s_and_b32 s77, s77, 0x1ffff
    v_exp_f32 v26, v26
    v_exp_f32 v27, v27
    v_cvt_pk_bf16_f32 v124, v24, v25
    v_cvt_pk_bf16_f32 v125, v26, v27
    v_exp_f32 v28, v28
    v_smfmac_f32_16x16x64_bf16 v[128:131], v[136:139], v[112:119], v205
    v_exp_f32 v29, v29
    v_exp_f32 v30, v30
    v_exp_f32 v31, v31
    v_cvt_pk_bf16_f32 v126, v28, v29
    v_cvt_pk_bf16_f32 v127, v30, v31
    s_cmp_eq_u32 s49, 0
    s_cbranch_scc0 L_pr_59
    s_setprio 2
L_pr_59:
    v_mfma_f32_32x32x16_bf16 v[16:31], v[156:159], v[104:107], v[48:63]
    v_exp_f32 v0, v0
    v_exp_f32 v1, v1
    v_exp_f32 v2, v2
    v_exp_f32 v3, v3
    v_mfma_f32_32x32x16_bf16 v[16:31], v[160:163], v[108:111], v[16:31]
    buffer_load_dwordx4 v[140:143], v204, s[12:15], s77 offen
    v_cvt_pk_bf16_f32 v112, v0, v1
    v_cvt_pk_bf16_f32 v113, v2, v3
    v_exp_f32 v4, v4
    v_exp_f32 v5, v5
    v_exp_f32 v6, v6
    v_mfma_f32_32x32x16_bf16 v[80:95], v[148:151], v[120:123], v[80:95]
    v_exp_f32 v7, v7
    v_cvt_pk_bf16_f32 v114, v4, v5
    v_cvt_pk_bf16_f32 v115, v6, v7
    v_exp_f32 v8, v8
    v_exp_f32 v9, v9
    v_mfma_f32_32x32x16_bf16 v[80:95], v[152:155], v[124:127], v[80:95]
    buffer_load_dwordx4 v[144:147], v204, s[12:15], s77 offen offset:1024
    v_exp_f32 v10, v10
    v_exp_f32 v11, v11
    v_cvt_pk_bf16_f32 v116, v8, v9
    v_cvt_pk_bf16_f32 v117, v10, v11
    v_exp_f32 v12, v12
    v_smfmac_f32_16x16x64_bf16 v[132:135], v[136:139], v[120:127], v205
    v_exp_f32 v13, v13
    v_exp_f32 v14, v14
    v_exp_f32 v15, v15
    v_cvt_pk_bf16_f32 v118, v12, v13
    v_cvt_pk_bf16_f32 v119, v14, v15
    s_waitcnt vmcnt(10)
    v_mfma_f32_32x32x16_bf16 v[0:15], v[172:175], v[96:99], v[32:47]
    v_exp_f32 v16, v16
    v_exp_f32 v17, v17
    v_exp_f32 v18, v18
    v_exp_f32 v19, v19
    v_mfma_f32_32x32x16_bf16 v[0:15], v[176:179], v[100:103], v[0:15]
    buffer_load_dwordx4 v[148:151], v204, s[12:15], s77 offen offset:2048
    v_cvt_pk_bf16_f32 v120, v16, v17
    v_cvt_pk_bf16_f32 v121, v18, v19
    v_exp_f32 v20, v20
    v_exp_f32 v21, v21
    v_exp_f32 v22, v22
    v_mfma_f32_32x32x16_bf16 v[64:79], v[164:167], v[112:115], v[64:79]
    v_exp_f32 v23, v23
    v_cvt_pk_bf16_f32 v122, v20, v21
    v_cvt_pk_bf16_f32 v123, v22, v23
    v_exp_f32 v24, v24
    v_exp_f32 v25, v25
    v_mfma_f32_32x32x16_bf16 v[64:79], v[168:171], v[116:119], v[64:79]
    buffer_load_dwordx4 v[152:155], v204, s[12:15], s77 offen offset:3072
    s_add_u32 s77, s77, 4096
    s_and_b32 s77, s77, 0x1ffff
    v_exp_f32 v26, v26
    v_exp_f32 v27, v27
    v_cvt_pk_bf16_f32 v124, v24, v25
    v_cvt_pk_bf16_f32 v125, v26, v27
    v_exp_f32 v28, v28
    v_smfmac_f32_16x16x64_bf16 v[128:131], v[136:139], v[112:119], v205
    v_exp_f32 v29, v29
    v_exp_f32 v30, v30
    v_exp_f32 v31, v31
    v_cvt_pk_bf16_f32 v126, v28, v29
    v_cvt_pk_bf16_f32 v127, v30, v31
    v_mfma_f32_32x32x16_bf16 v[16:31], v[172:175], v[104:107], v[48:63]
    v_exp_f32 v0, v0
    v_exp_f32 v1, v1
    v_exp_f32 v2, v2
    v_exp_f32 v3, v3
    v_mfma_f32_32x32x16_bf16 v[16:31], v[176:179], v[108:111], v[16:31]
    buffer_load_dwordx4 v[156:159], v204, s[12:15], s77 offen
    v_cvt_pk_bf16_f32 v112, v0, v1
    v_cvt_pk_bf16_f32 v113, v2, v3
    v_exp_f32 v4, v4
    v_exp_f32 v5, v5
    v_exp_f32 v6, v6
    v_mfma_f32_32x32x16_bf16 v[80:95], v[164:167], v[120:123], v[80:95]
    v_exp_f32 v7, v7
    v_cvt_pk_bf16_f32 v114, v4, v5
    v_cvt_pk_bf16_f32 v115, v6, v7
    v_exp_f32 v8, v8
    v_exp_f32 v9, v9
    v_mfma_f32_32x32x16_bf16 v[80:95], v[168:171], v[124:127], v[80:95]
    buffer_load_dwordx4 v[160:163], v204, s[12:15], s77 offen offset:1024
    v_exp_f32 v10, v10
    v_exp_f32 v11, v11
    v_cvt_pk_bf16_f32 v116, v8, v9
    v_cvt_pk_bf16_f32 v117, v10, v11
    v_exp_f32 v12, v12
    v_smfmac_f32_16x16x64_bf16 v[132:135], v[136:139], v[120:127], v205
    v_exp_f32 v13, v13
    v_exp_f32 v14, v14
    v_exp_f32 v15, v15
    v_cvt_pk_bf16_f32 v118, v12, v13
    v_cvt_pk_bf16_f32 v119, v14, v15
    s_waitcnt vmcnt(8)
    v_mfma_f32_32x32x16_bf16 v[0:15], v[188:191], v[96:99], v[32:47]
    v_exp_f32 v16, v16
    v_exp_f32 v17, v17
    v_exp_f32 v18, v18
    v_exp_f32 v19, v19
    v_mfma_f32_32x32x16_bf16 v[0:15], v[192:195], v[100:103], v[0:15]
    buffer_load_dwordx4 v[164:167], v204, s[12:15], s77 offen offset:2048
    v_cvt_pk_bf16_f32 v120, v16, v17
    v_cvt_pk_bf16_f32 v121, v18, v19
    v_exp_f32 v20, v20
    v_exp_f32 v21, v21
    v_exp_f32 v22, v22
    v_mfma_f32_32x32x16_bf16 v[64:79], v[180:183], v[112:115], v[64:79]
    v_exp_f32 v23, v23
    v_cvt_pk_bf16_f32 v122, v20, v21
    v_cvt_pk_bf16_f32 v123, v22, v23
    v_exp_f32 v24, v24
    v_exp_f32 v25, v25
    v_mfma_f32_32x32x16_bf16 v[64:79], v[184:187], v[116:119], v[64:79]
    buffer_load_dwordx4 v[168:171], v204, s[12:15], s77 offen offset:3072
    s_add_u32 s77, s77, 4096
    s_and_b32 s77, s77, 0x1ffff
    v_exp_f32 v26, v26
    v_exp_f32 v27, v27
    v_cvt_pk_bf16_f32 v124, v24, v25
    v_cvt_pk_bf16_f32 v125, v26, v27
    v_exp_f32 v28, v28
    v_smfmac_f32_16x16x64_bf16 v[128:131], v[136:139], v[112:119], v205
    v_exp_f32 v29, v29
    v_exp_f32 v30, v30
    v_exp_f32 v31, v31
    v_cvt_pk_bf16_f32 v126, v28, v29
    v_cvt_pk_bf16_f32 v127, v30, v31
    s_cmp_eq_u32 s49, 0
    s_cbranch_scc0 L_pr_60
    s_setprio 0
L_pr_60:
    v_mfma_f32_32x32x16_bf16 v[16:31], v[188:191], v[104:107], v[48:63]
    v_exp_f32 v0, v0
    v_exp_f32 v1, v1
    v_exp_f32 v2, v2
    v_exp_f32 v3, v3
    v_mfma_f32_32x32x16_bf16 v[16:31], v[192:195], v[108:111], v[16:31]
    buffer_load_dwordx4 v[172:175], v204, s[12:15], s77 offen
    v_cvt_pk_bf16_f32 v112, v0, v1
    v_cvt_pk_bf16_f32 v113, v2, v3
    v_exp_f32 v4, v4
    v_exp_f32 v5, v5
    v_exp_f32 v6, v6
    v_mfma_f32_32x32x16_bf16 v[80:95], v[180:183], v[120:123], v[80:95]
    v_exp_f32 v7, v7
    v_cvt_pk_bf16_f32 v114, v4, v5
    v_cvt_pk_bf16_f32 v115, v6, v7
    v_exp_f32 v8, v8
    v_exp_f32 v9, v9
    v_mfma_f32_32x32x16_bf16 v[80:95], v[184:187], v[124:127], v[80:95]
    buffer_load_dwordx4 v[176:179], v204, s[12:15], s77 offen offset:1024
    v_exp_f32 v10, v10
    v_exp_f32 v11, v11
    v_cvt_pk_bf16_f32 v116, v8, v9
    v_cvt_pk_bf16_f32 v117, v10, v11
    v_exp_f32 v12, v12
    v_smfmac_f32_16x16x64_bf16 v[132:135], v[136:139], v[120:127], v205
    v_exp_f32 v13, v13
    v_exp_f32 v14, v14
    v_exp_f32 v15, v15
    v_cvt_pk_bf16_f32 v118, v12, v13
    v_cvt_pk_bf16_f32 v119, v14, v15
    s_waitcnt vmcnt(8)
    s_mov_b32 s65, 0x1310000
    v_mfma_f32_32x32x16_bf16 v[0:15], v[140:143], v[96:99], v[32:47]
    buffer_load_dword v231, v229, s[12:15], s65 offen sc1
    v_exp_f32 v16, v16
    v_exp_f32 v17, v17
    v_exp_f32 v18, v18
    v_exp_f32 v19, v19
    v_mfma_f32_32x32x16_bf16 v[0:15], v[144:147], v[100:103], v[0:15]
    v_cvt_pk_bf16_f32 v120, v16, v17
    v_cvt_pk_bf16_f32 v121, v18, v19
    v_exp_f32 v20, v20
    v_exp_f32 v21, v21
    v_exp_f32 v22, v22
    v_mfma_f32_32x32x16_bf16 v[64:79], v[196:199], v[112:115], v[64:79]
    buffer_load_dwordx4 v[180:183], v204, s[12:15], s77 offen offset:2048
    v_exp_f32 v23, v23
    v_cvt_pk_bf16_f32 v122, v20, v21
    v_cvt_pk_bf16_f32 v123, v22, v23
    v_exp_f32 v24, v24
    v_exp_f32 v25, v25
    v_mfma_f32_32x32x16_bf16 v[64:79], v[200:203], v[116:119], v[64:79]
    buffer_load_dwordx4 v[184:187], v204, s[12:15], s77 offen offset:3072
    s_add_u32 s77, s77, 4096
    s_and_b32 s77, s77, 0x1ffff
    v_exp_f32 v26, v26
    v_exp_f32 v27, v27
    v_cvt_pk_bf16_f32 v124, v24, v25
    v_cvt_pk_bf16_f32 v125, v26, v27
    v_exp_f32 v28, v28
    v_smfmac_f32_16x16x64_bf16 v[128:131], v[136:139], v[112:119], v205
    v_exp_f32 v29, v29
    v_exp_f32 v30, v30
    v_exp_f32 v31, v31
    v_cvt_pk_bf16_f32 v126, v28, v29
    v_cvt_pk_bf16_f32 v127, v30, v31
    s_cmp_eq_u32 s49, 0
    s_cbranch_scc0 L_pr_61
    s_setprio 2
L_pr_61:
    v_mfma_f32_32x32x16_bf16 v[16:31], v[140:143], v[104:107], v[48:63]
    v_exp_f32 v0, v0
    v_exp_f32 v1, v1
    v_exp_f32 v2, v2
    v_exp_f32 v3, v3
    v_mfma_f32_32x32x16_bf16 v[16:31], v[144:147], v[108:111], v[16:31]
    buffer_load_dwordx4 v[188:191], v204, s[12:15], s77 offen
    v_cvt_pk_bf16_f32 v112, v0, v1
    v_cvt_pk_bf16_f32 v113, v2, v3
    v_exp_f32 v4, v4
    v_exp_f32 v5, v5
    v_exp_f32 v6, v6
    v_mfma_f32_32x32x16_bf16 v[80:95], v[196:199], v[120:123], v[80:95]
    v_exp_f32 v7, v7
    v_cvt_pk_bf16_f32 v114, v4, v5
    v_cvt_pk_bf16_f32 v115, v6, v7
    v_exp_f32 v8, v8
    v_exp_f32 v9, v9
    v_mfma_f32_32x32x16_bf16 v[80:95], v[200:203], v[124:127], v[80:95]
    buffer_load_dwordx4 v[192:195], v204, s[12:15], s77 offen offset:1024
    v_exp_f32 v10, v10
    v_exp_f32 v11, v11
    v_cvt_pk_bf16_f32 v116, v8, v9
    v_cvt_pk_bf16_f32 v117, v10, v11
    v_exp_f32 v12, v12
    v_smfmac_f32_16x16x64_bf16 v[132:135], v[136:139], v[120:127], v205
    v_exp_f32 v13, v13
    v_exp_f32 v14, v14
    v_exp_f32 v15, v15
    v_cvt_pk_bf16_f32 v118, v12, v13
    v_cvt_pk_bf16_f32 v119, v14, v15
    s_waitcnt vmcnt(9)
    v_mfma_f32_32x32x16_bf16 v[0:15], v[156:159], v[96:99], v[32:47]
    v_exp_f32 v16, v16
    v_exp_f32 v17, v17
    v_exp_f32 v18, v18
    v_exp_f32 v19, v19
    v_mfma_f32_32x32x16_bf16 v[0:15], v[160:163], v[100:103], v[0:15]
    buffer_load_dwordx4 v[196:199], v204, s[12:15], s77 offen offset:2048
    v_cvt_pk_bf16_f32 v120, v16, v17
    v_cvt_pk_bf16_f32 v121, v18, v19
    v_exp_f32 v20, v20
    v_exp_f32 v21, v21
    v_exp_f32 v22, v22
    v_mfma_f32_32x32x16_bf16 v[64:79], v[148:151], v[112:115], v[64:79]
    v_exp_f32 v23, v23
    v_cvt_pk_bf16_f32 v122, v20, v21
    v_cvt_pk_bf16_f32 v123, v22, v23
    v_exp_f32 v24, v24
    v_exp_f32 v25, v25
    v_mfma_f32_32x32x16_bf16 v[64:79], v[152:155], v[116:119], v[64:79]
    buffer_load_dwordx4 v[200:203], v204, s[12:15], s77 offen offset:3072
    s_add_u32 s77, s77, 4096
    s_and_b32 s77, s77, 0x1ffff
    v_exp_f32 v26, v26
    v_exp_f32 v27, v27
    v_cvt_pk_bf16_f32 v124, v24, v25
    v_cvt_pk_bf16_f32 v125, v26, v27
    v_exp_f32 v28, v28
    v_smfmac_f32_16x16x64_bf16 v[128:131], v[136:139], v[112:119], v205
    v_exp_f32 v29, v29
    v_exp_f32 v30, v30
    v_exp_f32 v31, v31
    v_cvt_pk_bf16_f32 v126, v28, v29
    v_cvt_pk_bf16_f32 v127, v30, v31
    s_waitcnt vmcnt(6)
    v_cmp_ne_u32 vcc, 1, v231
    s_cbranch_vccz L_flagok_62
    s_mov_b32 s71, 0
    s_mov_b32 s68, 0x1310000
L_poll_63:
    buffer_load_dword v231, v229, s[12:15], s68 offen sc1
    s_waitcnt vmcnt(0)
    v_cmp_ne_u32 vcc, 1, v231
    s_cbranch_vccz L_polled_64
    s_add_u32 s71, s71, 1
    s_cmp_ge_u32 s71, 0x10000
    s_cbranch_scc1 L_polled_64
    s_sleep 1
    s_branch L_poll_63
L_polled_64:
L_flagok_62:
    v_mfma_f32_32x32x16_bf16 v[16:31], v[156:159], v[104:107], v[48:63]
    v_exp_f32 v0, v0
    v_exp_f32 v1, v1
    v_exp_f32 v2, v2
    v_exp_f32 v3, v3
    v_mfma_f32_32x32x16_bf16 v[16:31], v[160:163], v[108:111], v[16:31]
    v_cvt_pk_bf16_f32 v112, v0, v1
    v_cvt_pk_bf16_f32 v113, v2, v3
    v_exp_f32 v4, v4
    v_exp_f32 v5, v5
    v_exp_f32 v6, v6
    v_mfma_f32_32x32x16_bf16 v[80:95], v[148:151], v[120:123], v[80:95]
    v_exp_f32 v7, v7
    v_cvt_pk_bf16_f32 v114, v4, v5
    v_cvt_pk_bf16_f32 v115, v6, v7
    v_exp_f32 v8, v8
    v_exp_f32 v9, v9
    v_mfma_f32_32x32x16_bf16 v[80:95], v[152:155], v[124:127], v[80:95]
    v_exp_f32 v10, v10
    v_exp_f32 v11, v11
    v_cvt_pk_bf16_f32 v116, v8, v9
    v_cvt_pk_bf16_f32 v117, v10, v11
    v_exp_f32 v12, v12
    v_smfmac_f32_16x16x64_bf16 v[132:135], v[136:139], v[120:127], v205
    v_exp_f32 v13, v13
    v_exp_f32 v14, v14
    v_exp_f32 v15, v15
    v_cvt_pk_bf16_f32 v118, v12, v13
    v_cvt_pk_bf16_f32 v119, v14, v15
    s_add_u32 s86, s85, 0
    s_and_b32 s86, s86, 7
    s_lshl_b32 s86, s86, 12
    v_mfma_f32_32x32x16_bf16 v[0:15], v[172:175], v[96:99], v[32:47]
    buffer_load_dwordx4 v[140:143], v225, s[12:15], s86 offen sc1
    v_exp_f32 v16, v16
    v_exp_f32 v17, v17
    v_exp_f32 v18, v18
    v_exp_f32 v19, v19
    v_mfma_f32_32x32x16_bf16 v[0:15], v[176:179], v[100:103], v[0:15]
    buffer_load_dwordx4 v[144:147], v225, s[12:15], s86 offen offset:1024 sc1
    v_cvt_pk_bf16_f32 v120, v16, v17
    v_cvt_pk_bf16_f32 v121, v18, v19
    v_exp_f32 v20, v20
    v_exp_f32 v21, v21
    v_exp_f32 v22, v22
    v_mfma_f32_32x32x16_bf16 v[64:79], v[164:167], v[112:115], v[64:79]
    buffer_load_dwordx4 v[148:151], v225, s[12:15], s86 offen offset:2048 sc1
    v_exp_f32 v23, v23
    v_cvt_pk_bf16_f32 v122, v20, v21
    v_cvt_pk_bf16_f32 v123, v22, v23
    v_exp_f32 v24, v24
    v_exp_f32 v25, v25
    v_mfma_f32_32x32x16_bf16 v[64:79], v[168:171], v[116:119], v[64:79]
    buffer_load_dwordx4 v[152:155], v225, s[12:15], s86 offen offset:3072 sc1
    v_exp_f32 v26, v26
    v_exp_f32 v27, v27
    v_cvt_pk_bf16_f32 v124, v24, v25
    v_cvt_pk_bf16_f32 v125, v26, v27
    v_exp_f32 v28, v28
    v_smfmac_f32_16x16x64_bf16 v[128:131], v[136:139], v[112:119], v205
    v_exp_f32 v29, v29
    v_exp_f32 v30, v30
    v_exp_f32 v31, v31
    v_cvt_pk_bf16_f32 v126, v28, v29
    v_cvt_pk_bf16_f32 v127, v30, v31
    s_cmp_eq_u32 s49, 0
    s_cbranch_scc0 L_pr_65
    s_setprio 0
L_pr_65:
    v_mfma_f32_32x32x16_bf16 v[16:31], v[172:175], v[104:107], v[48:63]
    v_exp_f32 v0, v0
    v_exp_f32 v1, v1
    v_exp_f32 v2, v2
    v_exp_f32 v3, v3
    v_mfma_f32_32x32x16_bf16 v[16:31], v[176:179], v[108:111], v[16:31]
    v_cvt_pk_bf16_f32 v112, v0, v1
    v_cvt_pk_bf16_f32 v113, v2, v3
    v_exp_f32 v4, v4
    v_exp_f32 v5, v5
    v_exp_f32 v6, v6
    v_mfma_f32_32x32x16_bf16 v[80:95], v[164:167], v[120:123], v[80:95]
    v_exp_f32 v7, v7
    v_cvt_pk_bf16_f32 v114, v4, v5
    v_cvt_pk_bf16_f32 v115, v6, v7
    v_exp_f32 v8, v8
    v_exp_f32 v9, v9
    v_mfma_f32_32x32x16_bf16 v[80:95], v[168:171], v[124:127], v[80:95]
    v_exp_f32 v10, v10
    v_exp_f32 v11, v11
    v_cvt_pk_bf16_f32 v116, v8, v9
    v_cvt_pk_bf16_f32 v117, v10, v11
    v_exp_f32 v12, v12
    v_smfmac_f32_16x16x64_bf16 v[132:135], v[136:139], v[120:127], v205
    v_exp_f32 v13, v13
    v_exp_f32 v14, v14
    v_exp_f32 v15, v15
    v_cvt_pk_bf16_f32 v118, v12, v13
    v_cvt_pk_bf16_f32 v119, v14, v15
    s_waitcnt vmcnt(6)
    s_add_u32 s86, s85, 1
    s_and_b32 s86, s86, 7
    s_lshl_b32 s86, s86, 12
    v_mfma_f32_32x32x16_bf16 v[0:15], v[188:191], v[96:99], v[32:47]
    buffer_load_dwordx4 v[156:159], v225, s[12:15], s86 offen sc1
    v_exp_f32 v16, v16
    v_exp_f32 v17, v17
    v_exp_f32 v18, v18
    v_exp_f32 v19, v19
    v_mfma_f32_32x32x16_bf16 v[0:15], v[192:195], v[100:103], v[0:15]
    buffer_load_dwordx4 v[160:163], v225, s[12:15], s86 offen offset:1024 sc1
    v_cvt_pk_bf16_f32 v120, v16, v17
    v_cvt_pk_bf16_f32 v121, v18, v19
    v_exp_f32 v20, v20
    v_exp_f32 v21, v21
    v_exp_f32 v22, v22
    v_mfma_f32_32x32x16_bf16 v[64:79], v[180:183], v[112:115], v[64:79]
    buffer_load_dwordx4 v[164:167], v225, s[12:15], s86 offen offset:2048 sc1
    v_exp_f32 v23, v23
    v_cvt_pk_bf16_f32 v122, v20, v21
    v_cvt_pk_bf16_f32 v123, v22, v23
    v_exp_f32 v24, v24
    v_exp_f32 v25, v25
    v_mfma_f32_32x32x16_bf16 v[64:79], v[184:187], v[116:119], v[64:79]
    buffer_load_dwordx4 v[168:171], v225, s[12:15], s86 offen offset:3072 sc1
    v_exp_f32 v26, v26
    v_exp_f32 v27, v27
    v_cvt_pk_bf16_f32 v124, v24, v25
    v_cvt_pk_bf16_f32 v125, v26, v27
    v_exp_f32 v28, v28
    v_smfmac_f32_16x16x64_bf16 v[128:131], v[136:139], v[112:119], v205
    v_exp_f32 v29, v29
    v_exp_f32 v30, v30
    v_exp_f32 v31, v31
    v_cvt_pk_bf16_f32 v126, v28, v29
    v_cvt_pk_bf16_f32 v127, v30, v31
    s_cmp_eq_u32 s49, 0
    s_cbranch_scc0 L_pr_66
    s_setprio 2
L_pr_66:
    v_mfma_f32_32x32x16_bf16 v[16:31], v[188:191], v[104:107], v[48:63]
    v_exp_f32 v0, v0
    v_exp_f32 v1, v1
    v_exp_f32 v2, v2
    v_exp_f32 v3, v3
    v_mfma_f32_32x32x16_bf16 v[16:31], v[192:195], v[108:111], v[16:31]
    v_cvt_pk_bf16_f32 v112, v0, v1
    v_cvt_pk_bf16_f32 v113, v2, v3
    v_exp_f32 v4, v4
    v_exp_f32 v5, v5
    v_exp_f32 v6, v6
    v_mfma_f32_32x32x16_bf16 v[80:95], v[180:183], v[120:123], v[80:95]
    v_exp_f32 v7, v7
    v_cvt_pk_bf16_f32 v114, v4, v5
    v_cvt_pk_bf16_f32 v115, v6, v7
    v_exp_f32 v8, v8
    v_exp_f32 v9, v9
    v_mfma_f32_32x32x16_bf16 v[80:95], v[184:187], v[124:127], v[80:95]
    v_exp_f32 v10, v10
    v_exp_f32 v11, v11
    v_cvt_pk_bf16_f32 v116, v8, v9
    v_cvt_pk_bf16_f32 v117, v10, v11
    v_exp_f32 v12, v12
    v_smfmac_f32_16x16x64_bf16 v[132:135], v[136:139], v[120:127], v205
    v_exp_f32 v13, v13
    v_exp_f32 v14, v14
    v_exp_f32 v15, v15
    v_cvt_pk_bf16_f32 v118, v12, v13
    v_cvt_pk_bf16_f32 v119, v14, v15
    s_waitcnt vmcnt(8)
    s_add_u32 s86, s85, 2
    s_and_b32 s86, s86, 7
    s_lshl_b32 s86, s86, 12
    v_mfma_f32_32x32x16_bf16 v[64:79], v[196:199], v[112:115], v[64:79]
    buffer_load_dwordx4 v[172:175], v225, s[12:15], s86 offen sc1
    buffer_load_dwordx4 v[176:179], v225, s[12:15], s86 offen offset:1024 sc1
    v_exp_f32 v16, v16
    v_exp_f32 v17, v17
    v_exp_f32 v18, v18
    v_exp_f32 v19, v19
    v_cvt_pk_bf16_f32 v120, v16, v17
    v_cvt_pk_bf16_f32 v121, v18, v19
    v_exp_f32 v20, v20
    v_exp_f32 v21, v21
    v_mfma_f32_32x32x16_bf16 v[64:79], v[200:203], v[116:119], v[64:79]
    buffer_load_dwordx4 v[180:183], v225, s[12:15], s86 offen offset:2048 sc1
    v_exp_f32 v22, v22
    v_exp_f32 v23, v23
    v_cvt_pk_bf16_f32 v122, v20, v21
    v_cvt_pk_bf16_f32 v123, v22, v23
    v_exp_f32 v24, v24
    v_exp_f32 v25, v25
    v_exp_f32 v26, v26
    v_exp_f32 v27, v27
    v_smfmac_f32_16x16x64_bf16 v[128:131], v[136:139], v[112:119], v205
    buffer_load_dwordx4 v[184:187], v225, s[12:15], s86 offen offset:3072 sc1
    v_cvt_pk_bf16_f32 v124, v24, v25
    v_cvt_pk_bf16_f32 v125, v26, v27
    v_exp_f32 v28, v28
    v_exp_f32 v29, v29
    v_exp_f32 v30, v30
    v_exp_f32 v31, v31
    v_cvt_pk_bf16_f32 v126, v28, v29
    v_cvt_pk_bf16_f32 v127, v30, v31
    s_setprio 0
    v_mfma_f32_32x32x16_bf16 v[80:95], v[196:199], v[120:123], v[80:95]
    v_mfma_f32_32x32x16_bf16 v[80:95], v[200:203], v[124:127], v[80:95]
    v_smfmac_f32_16x16x64_bf16 v[132:135], v[136:139], v[120:127], v205
    v_add_f32 v128, v128, v129
    s_nop 10
    v_add_f32 v132, v132, v133
    v_add_f32 v207, v128, v132
    v_pk_add_f32 v[0:1], v[64:65], v[66:67]
    v_pk_add_f32 v[0:1], v[0:1], v[68:69]
    v_pk_add_f32 v[0:1], v[0:1], v[70:71]
    v_pk_add_f32 v[0:1], v[0:1], v[72:73]
    v_pk_add_f32 v[0:1], v[0:1], v[74:75]
    v_pk_add_f32 v[0:1], v[0:1], v[76:77]
    v_pk_add_f32 v[0:1], v[0:1], v[78:79]
    v_pk_add_f32 v[0:1], v[0:1], v[80:81]
    v_pk_add_f32 v[0:1], v[0:1], v[82:83]
    v_pk_add_f32 v[0:1], v[0:1], v[84:85]
    v_pk_add_f32 v[0:1], v[0:1], v[86:87]
    v_pk_add_f32 v[0:1], v[0:1], v[88:89]
    v_pk_add_f32 v[0:1], v[0:1], v[90:91]
    v_pk_add_f32 v[0:1], v[0:1], v[92:93]
    v_pk_add_f32 v[0:1], v[0:1], v[94:95]
    v_add_f32 v207, v207, v0
    v_add_f32 v207, v207, v1
    v_mov_b32 v206, 0x207
    v_cmp_class_f32 vcc, v207, v206
    s_cbranch_vccnz L_retry
L_attn_done:
    s_add_u32 s86, s85, 3
    s_and_b32 s86, s86, 7
    s_lshl_b32 s86, s86, 12
    buffer_load_dwordx4 v[188:191], v225, s[12:15], s86 offen sc1
    buffer_load_dwordx4 v[192:195], v225, s[12:15], s86 offen offset:1024 sc1
    buffer_load_dwordx4 v[196:199], v225, s[12:15], s86 offen offset:2048 sc1
    buffer_load_dwordx4 v[200:203], v225, s[12:15], s86 offen offset:3072 sc1
    v_xor_b32 v208, 512, v226
    v_xor_b32 v209, 512, v227
    s_and_b32 s64, s85, 3
    s_lshl_b32 s64, s64, 2
    s_lshr_b32 s65, 0x54105410, s64
    s_and_b32 s65, s65, 0xffff
    s_mul_i32 s65, s65, 0x10001
    s_or_b32 s58, s65, 0x2222
    s_lshl_b32 s64, s49, 3
    s_lshl_b32 s59, 0xcc, s64
    s_lshl_b32 s60, 0x33, s64
    v_sub_f32 v205, 0, v32
    v_sub_f32 v206, 0, v48
    v_rcp_f32 v133, v132
    v_log_f32 v134, v132
    s_mul_i32 s64, s48, 2304
    s_add_u32 s64, s64, 0x20000
    v_add_u32 v232, s64, v254
    v_lshlrev_b32 v233, 2, v253
    v_add_u32 v234, s64, v233
    v_add_f32 v134, v134, v206
    s_mov_b32 s8, s38
    s_mov_b32 s9, s39
    v_mul_f32 v80, v80, v133
    v_mul_f32 v81, v81, v133
    v_mul_f32 v82, v82, v133
    v_mul_f32 v83, v83, v133
    v_mul_f32 v84, v84, v133
    v_mul_f32 v85, v85, v133
    v_mul_f32 v86, v86, v133
    v_mul_f32 v87, v87, v133
    v_cvt_pk_bf16_f32 v0, v80, v81
    v_cvt_pk_bf16_f32 v1, v82, v83
    v_cvt_pk_bf16_f32 v2, v84, v85
    v_cvt_pk_bf16_f32 v3, v86, v87
    ds_write_b128 v232, v[0:3] offset:0
    v_mul_f32 v88, v88, v133
    v_mul_f32 v89, v89, v133
    v_mul_f32 v90, v90, v133
    v_mul_f32 v91, v91, v133
    v_mul_f32 v92, v92, v133
    v_mul_f32 v93, v93, v133
    v_mul_f32 v94, v94, v133
    v_mul_f32 v95, v95, v133
    v_cvt_pk_bf16_f32 v4, v88, v89
    v_cvt_pk_bf16_f32 v5, v90, v91
    v_cvt_pk_bf16_f32 v6, v92, v93
    v_cvt_pk_bf16_f32 v7, v94, v95
    ds_write_b128 v232, v[4:7] offset:1024
    s_add_u32 s86, s85, 6
    s_and_b32 s86, s86, 7
    s_lshl_b32 s86, s86, 12
    buffer_load_dwordx4 v[96:99], v225, s[12:15], s86 offen sc1
    ds_write_b32 v234, v134 offset:2048
    v_rcp_f32 v129, v128
    v_log_f32 v130, v128
    buffer_load_dwordx4 v[100:103], v225, s[12:15], s86 offen offset:1024 sc1
    s_xor_b32 s65, s48, 4
    s_mul_i32 s64, s65, 2304
    s_add_u32 s64, s64, 0x20000
    buffer_load_dwordx4 v[104:107], v225, s[12:15], s86 offen offset:2048 sc1
    v_add_u32 v232, s64, v254
    v_add_u32 v234, s64, v233
    v_add_f32 v130, v130, v205
    buffer_load_dwordx4 v[108:111], v225, s[12:15], s86 offen offset:3072 sc1
    v_mul_f32 v64, v64, v129
    v_mul_f32 v65, v65, v129
    v_mul_f32 v66, v66, v129
    s_add_u32 s86, s85, 7
    s_and_b32 s86, s86, 7
    s_lshl_b32 s86, s86, 12
    buffer_load_dwordx4 v[112:115], v225, s[12:15], s86 offen sc1
    v_mul_f32 v67, v67, v129
    v_mul_f32 v68, v68, v129
    v_mul_f32 v69, v69, v129
    buffer_load_dwordx4 v[116:119], v225, s[12:15], s86 offen offset:1024 sc1
    v_mul_f32 v70, v70, v129
    v_mul_f32 v71, v71, v129
    v_mul_f32 v72, v72, v129
    buffer_load_dwordx4 v[120:123], v225, s[12:15], s86 offen offset:2048 sc1
    v_mul_f32 v73, v73, v129
    v_mul_f32 v74, v74, v129
    v_mul_f32 v75, v75, v129
    buffer_load_dwordx4 v[124:127], v225, s[12:15], s86 offen offset:3072 sc1
    v_mul_f32 v76, v76, v129
    v_mul_f32 v77, v77, v129
    v_mul_f32 v78, v78, v129
    v_mul_f32 v79, v79, v129
    s_waitcnt lgkmcnt(0)
    s_barrier
    ds_read_b32 v16, v234 offset:2048
    ds_read_b128 v[8:11], v232 offset:0
    ds_read_b128 v[12:15], v232 offset:1024
    ds_read_b64_tr_b16 v[32:33], v226 offset:0
    ds_read_b64_tr_b16 v[34:35], v226 offset:1024
    ds_read_b64_tr_b16 v[36:37], v208 offset:0
    ds_read_b64_tr_b16 v[38:39], v208 offset:1024
    ds_read_b64_tr_b16 v[40:41], v226 offset:2048
    ds_read_b64_tr_b16 v[42:43], v226 offset:3072
    ds_read_b64_tr_b16 v[44:45], v208 offset:2048
    ds_read_b64_tr_b16 v[46:47], v208 offset:3072
    s_waitcnt lgkmcnt(10)
    v_max_f32 v20, v130, v16
    v_sub_f32 v21, v130, v20
    v_sub_f32 v22, v16, v20
    v_exp_f32 v21, v21
    v_exp_f32 v22, v22
    v_mov_b32 v24, 0xffff0000
    v_add_f32 v23, v21, v22
    v_rcp_f32 v23, v23
    s_nop 0
    v_mul_f32 v23, v23, v230
    v_mul_f32 v21, v21, v23
    v_mul_f32 v22, v22, v23
    s_waitcnt lgkmcnt(8)
    v_lshlrev_b32 v25, 16, v8
    v_and_b32 v26, v24, v8
    v_mul_f32 v64, v64, v21
    v_mul_f32 v65, v65, v21
    v_fma_f32 v64, v25, v22, v64
    v_fma_f32 v65, v26, v22, v65
    v_cvt_pk_bf16_f32 v128, v64, v65
    v_lshlrev_b32 v25, 16, v9
    v_and_b32 v26, v24, v9
    v_mul_f32 v66, v66, v21
    v_mul_f32 v67, v67, v21
    v_fma_f32 v66, v25, v22, v66
    v_fma_f32 v67, v26, v22, v67
    v_cvt_pk_bf16_f32 v129, v66, v67
    v_lshlrev_b32 v25, 16, v10
    v_and_b32 v26, v24, v10
    v_mul_f32 v68, v68, v21
    v_mul_f32 v69, v69, v21
    v_fma_f32 v68, v25, v22, v68
    v_fma_f32 v69, v26, v22, v69
    v_cvt_pk_bf16_f32 v130, v68, v69
    v_lshlrev_b32 v25, 16, v11
    v_and_b32 v26, v24, v11
    v_mul_f32 v70, v70, v21
    v_mul_f32 v71, v71, v21
    v_fma_f32 v70, v25, v22, v70
    v_fma_f32 v71, v26, v22, v71
    v_cvt_pk_bf16_f32 v131, v70, v71
    buffer_store_dwordx4 v[128:131], v254, s[12:15], s80 offen sc1
    v_lshlrev_b32 v25, 16, v12
    v_and_b32 v26, v24, v12
    v_mul_f32 v72, v72, v21
    v_mul_f32 v73, v73, v21
    v_fma_f32 v72, v25, v22, v72
    v_fma_f32 v73, v26, v22, v73
    v_cvt_pk_bf16_f32 v132, v72, v73
    v_lshlrev_b32 v25, 16, v13
    v_and_b32 v26, v24, v13
    v_mul_f32 v74, v74, v21
    v_mul_f32 v75, v75, v21
    v_fma_f32 v74, v25, v22, v74
    v_fma_f32 v75, v26, v22, v75
    v_cvt_pk_bf16_f32 v133, v74, v75
    v_lshlrev_b32 v25, 16, v14
    v_and_b32 v26, v24, v14
    v_mul_f32 v76, v76, v21
    v_mul_f32 v77, v77, v21
    v_fma_f32 v76, v25, v22, v76
    v_fma_f32 v77, v26, v22, v77
    v_cvt_pk_bf16_f32 v134, v76, v77
    v_lshlrev_b32 v25, 16, v15
    v_and_b32 v26, v24, v15
    v_mul_f32 v78, v78, v21
    v_mul_f32 v79, v79, v21
    v_fma_f32 v78, v25, v22, v78
    v_fma_f32 v79, v26, v22, v79
    v_cvt_pk_bf16_f32 v135, v78, v79
    buffer_store_dwordx4 v[132:135], v254, s[12:15], s80 offen offset:1024 sc1
    ds_read_b64_tr_b16 v[48:49], v226 offset:4096
    ds_read_b64_tr_b16 v[50:51], v226 offset:5120
    ds_read_b64_tr_b16 v[52:53], v208 offset:4096
    ds_read_b64_tr_b16 v[54:55], v208 offset:5120
    s_waitcnt lgkmcnt(8)
    s_waitcnt vmcnt(25)
    v_mfma_f32_32x32x16_bf16 v[0:15], v[32:35], v[140:143], 0
    v_mfma_f32_32x32x16_bf16 v[16:31], v[36:39], v[140:143], 0
    s_add_u32 s86, s85, 4
    s_and_b32 s86, s86, 7
    s_lshl_b32 s86, s86, 12
    buffer_load_dwordx4 v[64:67], v225, s[12:15], s86 offen sc1
    ds_read_b64_tr_b16 v[56:57], v226 offset:6144
    ds_read_b64_tr_b16 v[58:59], v226 offset:7168
    ds_read_b64_tr_b16 v[60:61], v208 offset:6144
    ds_read_b64_tr_b16 v[62:63], v208 offset:7168
    s_waitcnt lgkmcnt(8)
    s_waitcnt vmcnt(25)
    v_mfma_f32_32x32x16_bf16 v[0:15], v[40:43], v[144:147], v[0:15]
    v_mfma_f32_32x32x16_bf16 v[16:31], v[44:47], v[144:147], v[16:31]
    buffer_load_dwordx4 v[68:71], v225, s[12:15], s86 offen offset:1024 sc1
    ds_read_b64_tr_b16 v[32:33], v226 offset:16384
    ds_read_b64_tr_b16 v[34:35], v226 offset:17408
    ds_read_b64_tr_b16 v[36:37], v208 offset:16384
    ds_read_b64_tr_b16 v[38:39], v208 offset:17408
    s_waitcnt lgkmcnt(8)
    s_waitcnt vmcnt(25)
    v_mfma_f32_32x32x16_bf16 v[0:15], v[48:51], v[148:151], v[0:15]
    v_mfma_f32_32x32x16_bf16 v[16:31], v[52:55], v[148:151], v[16:31]
    buffer_load_dwordx4 v[72:75], v225, s[12:15], s86 offen offset:2048 sc1
    ds_read_b64_tr_b16 v[40:41], v226 offset:18432
    ds_read_b64_tr_b16 v[42:43], v226 offset:19456
    ds_read_b64_tr_b16 v[44:45], v208 offset:18432
    ds_read_b64_tr_b16 v[46:47], v208 offset:19456
    s_waitcnt lgkmcnt(8)
    s_waitcnt vmcnt(25)
    v_mfma_f32_32x32x16_bf16 v[0:15], v[56:59], v[152:155], v[0:15]
    v_mfma_f32_32x32x16_bf16 v[16:31], v[60:63], v[152:155], v[16:31]
    buffer_load_dwordx4 v[76:79], v225, s[12:15], s86 offen offset:3072 sc1
    ds_read_b64_tr_b16 v[48:49], v226 offset:20480
    ds_read_b64_tr_b16 v[50:51], v226 offset:21504
    ds_read_b64_tr_b16 v[52:53], v208 offset:20480
    ds_read_b64_tr_b16 v[54:55], v208 offset:21504
    s_waitcnt lgkmcnt(8)
    s_waitcnt vmcnt(25)
    v_mfma_f32_32x32x16_bf16 v[0:15], v[32:35], v[156:159], v[0:15]
    v_mfma_f32_32x32x16_bf16 v[16:31], v[36:39], v[156:159], v[16:31]
    s_waitcnt vmcnt(4)
    s_mov_b64 exec, 1
    v_mov_b32 v232, 0x27a0c
    v_mov_b32 v233, 1
    ds_add_rtn_u32 v233, v232, v233
    s_mov_b64 exec, -1
    s_add_u32 s86, s85, 5
    s_and_b32 s86, s86, 7
    s_lshl_b32 s86, s86, 12
    buffer_load_dwordx4 v[80:83], v225, s[12:15], s86 offen sc1
    ds_read_b64_tr_b16 v[56:57], v226 offset:22528
    ds_read_b64_tr_b16 v[58:59], v226 offset:23552
    ds_read_b64_tr_b16 v[60:61], v208 offset:22528
    ds_read_b64_tr_b16 v[62:63], v208 offset:23552
    s_waitcnt lgkmcnt(8)
    v_mfma_f32_32x32x16_bf16 v[0:15], v[40:43], v[160:163], v[0:15]
    v_mfma_f32_32x32x16_bf16 v[16:31], v[44:47], v[160:163], v[16:31]
    buffer_load_dwordx4 v[84:87], v225, s[12:15], s86 offen offset:1024 sc1
    ds_read_b64_tr_b16 v[32:33], v226 offset:32768
    ds_read_b64_tr_b16 v[34:35], v226 offset:33792
    ds_read_b64_tr_b16 v[36:37], v208 offset:32768
    ds_read_b64_tr_b16 v[38:39], v208 offset:33792
    s_waitcnt lgkmcnt(8)
    v_mfma_f32_32x32x16_bf16 v[0:15], v[48:51], v[164:167], v[0:15]
    v_mfma_f32_32x32x16_bf16 v[16:31], v[52:55], v[164:167], v[16:31]
    s_mov_b64 exec, 1
    v_cmp_ne_u32 vcc, 7, v233
    s_cbranch_vccnz L_noflagB_67
    v_mov_b32 v233, 1
    v_mov_b32 v232, 0
    buffer_store_dword v233, v232, s[12:15], s84 offen sc1
L_noflagB_67:
    s_mov_b64 exec, -1
    buffer_load_dwordx4 v[88:91], v225, s[12:15], s86 offen offset:2048 sc1
    ds_read_b64_tr_b16 v[40:41], v226 offset:34816
    ds_read_b64_tr_b16 v[42:43], v226 offset:35840
    ds_read_b64_tr_b16 v[44:45], v208 offset:34816
    ds_read_b64_tr_b16 v[46:47], v208 offset:35840
    s_waitcnt lgkmcnt(8)
    v_mfma_f32_32x32x16_bf16 v[0:15], v[56:59], v[168:171], v[0:15]
    v_mfma_f32_32x32x16_bf16 v[16:31], v[60:63], v[168:171], v[16:31]
    s_barrier
    buffer_load_dwordx4 v[92:95], v225, s[12:15], s86 offen offset:3072 sc1
    s_bfe_u32 s65, s58, 0x30000
    s_lshl_b32 s65, s65, 17
    s_add_u32 m0, s56, 0x0
    s_add_u32 s65, s65, 0x0
    buffer_load_dwordx4 v224, s[8:11], s65 offen lds
    ds_read_b64_tr_b16 v[48:49], v226 offset:36864
    ds_read_b64_tr_b16 v[50:51], v226 offset:37888
    ds_read_b64_tr_b16 v[52:53], v208 offset:36864
    ds_read_b64_tr_b16 v[54:55], v208 offset:37888
    s_waitcnt lgkmcnt(8)
    v_mfma_f32_32x32x16_bf16 v[0:15], v[32:35], v[172:175], v[0:15]
    v_mfma_f32_32x32x16_bf16 v[16:31], v[36:39], v[172:175], v[16:31]
    s_bfe_u32 s65, s58, 0x30000
    s_lshl_b32 s65, s65, 17
    s_add_u32 m0, s56, 0x400
    s_add_u32 s65, s65, 0x4000
    buffer_load_dwordx4 v224, s[8:11], s65 offen lds
    ds_read_b64_tr_b16 v[56:57], v226 offset:38912
    ds_read_b64_tr_b16 v[58:59], v226 offset:39936
    ds_read_b64_tr_b16 v[60:61], v208 offset:38912
    ds_read_b64_tr_b16 v[62:63], v208 offset:39936
    s_waitcnt lgkmcnt(8)
    v_mfma_f32_32x32x16_bf16 v[0:15], v[40:43], v[176:179], v[0:15]
    v_mfma_f32_32x32x16_bf16 v[16:31], v[44:47], v[176:179], v[16:31]
    s_bfe_u32 s65, s58, 0x30004
    s_lshl_b32 s65, s65, 17
    s_add_u32 m0, s56, 0x4000
    s_add_u32 s65, s65, 0x0
    buffer_load_dwordx4 v224, s[8:11], s65 offen lds
    ds_read_b64_tr_b16 v[32:33], v226 offset:49152
    ds_read_b64_tr_b16 v[34:35], v226 offset:50176
    ds_read_b64_tr_b16 v[36:37], v208 offset:49152
    ds_read_b64_tr_b16 v[38:39], v208 offset:50176
    s_waitcnt lgkmcnt(8)
    v_mfma_f32_32x32x16_bf16 v[0:15], v[48:51], v[180:183], v[0:15]
    v_mfma_f32_32x32x16_bf16 v[16:31], v[52:55], v[180:183], v[16:31]
    s_bfe_u32 s65, s58, 0x30004
    s_lshl_b32 s65, s65, 17
    s_add_u32 m0, s56, 0x4400
    s_add_u32 s65, s65, 0x4000
    buffer_load_dwordx4 v224, s[8:11], s65 offen lds
    ds_read_b64_tr_b16 v[40:41], v226 offset:51200
    ds_read_b64_tr_b16 v[42:43], v226 offset:52224
    ds_read_b64_tr_b16 v[44:45], v208 offset:51200
    ds_read_b64_tr_b16 v[46:47], v208 offset:52224
    s_waitcnt lgkmcnt(8)
    v_mfma_f32_32x32x16_bf16 v[0:15], v[56:59], v[184:187], v[0:15]
    v_mfma_f32_32x32x16_bf16 v[16:31], v[60:63], v[184:187], v[16:31]
    ds_read_b64_tr_b16 v[48:49], v226 offset:53248
    ds_read_b64_tr_b16 v[50:51], v226 offset:54272
    ds_read_b64_tr_b16 v[52:53], v208 offset:53248
    ds_read_b64_tr_b16 v[54:55], v208 offset:54272
    s_waitcnt lgkmcnt(8)
    v_mfma_f32_32x32x16_bf16 v[0:15], v[32:35], v[188:191], v[0:15]
    v_mfma_f32_32x32x16_bf16 v[16:31], v[36:39], v[188:191], v[16:31]
    ds_read_b64_tr_b16 v[56:57], v226 offset:55296
    ds_read_b64_tr_b16 v[58:59], v226 offset:56320
    ds_read_b64_tr_b16 v[60:61], v208 offset:55296
    ds_read_b64_tr_b16 v[62:63], v208 offset:56320
    s_waitcnt lgkmcnt(8)
    v_mfma_f32_32x32x16_bf16 v[0:15], v[40:43], v[192:195], v[0:15]
    v_mfma_f32_32x32x16_bf16 v[16:31], v[44:47], v[192:195], v[16:31]
    ds_read_b64_tr_b16 v[32:33], v227 offset:0
    ds_read_b64_tr_b16 v[34:35], v227 offset:1024
    ds_read_b64_tr_b16 v[36:37], v209 offset:0
    ds_read_b64_tr_b16 v[38:39], v209 offset:1024
    s_waitcnt lgkmcnt(8)
    v_mfma_f32_32x32x16_bf16 v[0:15], v[48:51], v[196:199], v[0:15]
    v_mfma_f32_32x32x16_bf16 v[16:31], v[52:55], v[196:199], v[16:31]
    ds_read_b64_tr_b16 v[40:41], v227 offset:2048
    ds_read_b64_tr_b16 v[42:43], v227 offset:3072
    ds_read_b64_tr_b16 v[44:45], v209 offset:2048
    ds_read_b64_tr_b16 v[46:47], v209 offset:3072
    s_waitcnt lgkmcnt(8)
    v_mfma_f32_32x32x16_bf16 v[0:15], v[56:59], v[200:203], v[0:15]
    v_mfma_f32_32x32x16_bf16 v[16:31], v[60:63], v[200:203], v[16:31]
    s_barrier
    s_bfe_u32 s65, s58, 0x30008
    s_lshl_b32 s65, s65, 17
    s_add_u32 m0, s56, 0x8000
    s_add_u32 s65, s65, 0x0
    buffer_load_dwordx4 v224, s[8:11], s65 offen lds
    ds_read_b64_tr_b16 v[48:49], v227 offset:4096
    ds_read_b64_tr_b16 v[50:51], v227 offset:5120
    ds_read_b64_tr_b16 v[52:53], v209 offset:4096
    ds_read_b64_tr_b16 v[54:55], v209 offset:5120
    s_waitcnt lgkmcnt(8)
    s_waitcnt vmcnt(12)
    v_mfma_f32_32x32x16_bf16 v[0:15], v[32:35], v[64:67], v[0:15]
    v_mfma_f32_32x32x16_bf16 v[16:31], v[36:39], v[64:67], v[16:31]
    s_mov_b32 s65, 0x1318000
    buffer_load_dword v231, v229, s[12:15], s65 offen sc1
    s_bfe_u32 s65, s58, 0x30008
    s_lshl_b32 s65, s65, 17
    s_add_u32 m0, s56, 0x8400
    s_add_u32 s65, s65, 0x4000
    buffer_load_dwordx4 v224, s[8:11], s65 offen lds
    ds_read_b64_tr_b16 v[56:57], v227 offset:6144
    ds_read_b64_tr_b16 v[58:59], v227 offset:7168
    ds_read_b64_tr_b16 v[60:61], v209 offset:6144
    ds_read_b64_tr_b16 v[62:63], v209 offset:7168
    s_waitcnt lgkmcnt(8)
    s_waitcnt vmcnt(13)
    v_mfma_f32_32x32x16_bf16 v[0:15], v[40:43], v[68:71], v[0:15]
    v_mfma_f32_32x32x16_bf16 v[16:31], v[44:47], v[68:71], v[16:31]
    s_bfe_u32 s65, s58, 0x3000c
    s_lshl_b32 s65, s65, 17
    s_add_u32 m0, s56, 0xc000
    s_add_u32 s65, s65, 0x0
    buffer_load_dwordx4 v224, s[8:11], s65 offen lds
    ds_read_b64_tr_b16 v[32:33], v227 offset:16384
    ds_read_b64_tr_b16 v[34:35], v227 offset:17408
    ds_read_b64_tr_b16 v[36:37], v209 offset:16384
    ds_read_b64_tr_b16 v[38:39], v209 offset:17408
    s_waitcnt lgkmcnt(8)
    s_waitcnt vmcnt(13)
    v_mfma_f32_32x32x16_bf16 v[0:15], v[48:51], v[72:75], v[0:15]
    v_mfma_f32_32x32x16_bf16 v[16:31], v[52:55], v[72:75], v[16:31]
    s_bfe_u32 s65, s58, 0x3000c
    s_lshl_b32 s65, s65, 17
    s_add_u32 m0, s56, 0xc400
    s_add_u32 s65, s65, 0x4000
    buffer_load_dwordx4 v224, s[8:11], s65 offen lds
    ds_read_b64_tr_b16 v[40:41], v227 offset:18432
    ds_read_b64_tr_b16 v[42:43], v227 offset:19456
    ds_read_b64_tr_b16 v[44:45], v209 offset:18432
    ds_read_b64_tr_b16 v[46:47], v209 offset:19456
    s_waitcnt lgkmcnt(8)
    s_waitcnt vmcnt(13)
    v_mfma_f32_32x32x16_bf16 v[0:15], v[56:59], v[76:79], v[0:15]
    v_mfma_f32_32x32x16_bf16 v[16:31], v[60:63], v[76:79], v[16:31]
    s_waitcnt vmcnt(3)
    v_cmp_ne_u32 vcc, 1, v231
    s_and_b32 s67, vcc_lo, s59
    s_cbranch_scc0 L_flagok_68
    s_mov_b32 s71, 0
    s_mov_b32 s68, 0x1318000
L_poll_69:
    buffer_load_dword v231, v229, s[12:15], s68 offen sc1
    s_waitcnt vmcnt(0)
    v_cmp_ne_u32 vcc, 1, v231
    s_and_b32 s67, vcc_lo, s59
    s_cbranch_scc0 L_flagok_68
    s_add_u32 s71, s71, 1
    s_cmp_ge_u32 s71, 0x10000
    s_cbranch_scc1 L_flagok_68
    s_sleep 1
    s_branch L_poll_69
L_flagok_68:
    ds_read_b64_tr_b16 v[48:49], v227 offset:20480
    ds_read_b64_tr_b16 v[50:51], v227 offset:21504
    ds_read_b64_tr_b16 v[52:53], v209 offset:20480
    ds_read_b64_tr_b16 v[54:55], v209 offset:21504
    s_waitcnt lgkmcnt(8)
    v_mfma_f32_32x32x16_bf16 v[0:15], v[32:35], v[80:83], v[0:15]
    v_mfma_f32_32x32x16_bf16 v[16:31], v[36:39], v[80:83], v[16:31]
    s_bfe_u32 s86, s58, 0x30000
    s_lshl_b32 s86, s86, 12
    s_add_u32 s86, s86, 65536
    buffer_load_dwordx4 v[140:143], v225, s[12:15], s86 offen sc1
    ds_read_b64_tr_b16 v[56:57], v227 offset:22528
    ds_read_b64_tr_b16 v[58:59], v227 offset:23552
    ds_read_b64_tr_b16 v[60:61], v209 offset:22528
    ds_read_b64_tr_b16 v[62:63], v209 offset:23552
    s_waitcnt lgkmcnt(8)
    v_mfma_f32_32x32x16_bf16 v[0:15], v[40:43], v[84:87], v[0:15]
    v_mfma_f32_32x32x16_bf16 v[16:31], v[44:47], v[84:87], v[16:31]
    buffer_load_dwordx4 v[144:147], v225, s[12:15], s86 offen offset:1024 sc1
    ds_read_b64_tr_b16 v[32:33], v227 offset:32768
    ds_read_b64_tr_b16 v[34:35], v227 offset:33792
    ds_read_b64_tr_b16 v[36:37], v209 offset:32768
    ds_read_b64_tr_b16 v[38:39], v209 offset:33792
    s_waitcnt lgkmcnt(8)
    v_mfma_f32_32x32x16_bf16 v[0:15], v[48:51], v[88:91], v[0:15]
    v_mfma_f32_32x32x16_bf16 v[16:31], v[52:55], v[88:91], v[16:31]
    buffer_load_dwordx4 v[148:151], v225, s[12:15], s86 offen offset:2048 sc1
    ds_read_b64_tr_b16 v[40:41], v227 offset:34816
    ds_read_b64_tr_b16 v[42:43], v227 offset:35840
    ds_read_b64_tr_b16 v[44:45], v209 offset:34816
    ds_read_b64_tr_b16 v[46:47], v209 offset:35840
    s_waitcnt lgkmcnt(8)
    v_mfma_f32_32x32x16_bf16 v[0:15], v[56:59], v[92:95], v[0:15]
    v_mfma_f32_32x32x16_bf16 v[16:31], v[60:63], v[92:95], v[16:31]
    s_barrier
    s_bfe_u32 s65, s58, 0x30010
    s_lshl_b32 s65, s65, 17
    s_add_u32 m0, s56, 0x10000
    s_add_u32 s65, s65, 0x0
    buffer_load_dwordx4 v224, s[8:11], s65 offen lds
    buffer_load_dwordx4 v[152:155], v225, s[12:15], s86 offen offset:3072 sc1
    ds_read_b64_tr_b16 v[48:49], v227 offset:36864
    ds_read_b64_tr_b16 v[50:51], v227 offset:37888
    ds_read_b64_tr_b16 v[52:53], v209 offset:36864
    ds_read_b64_tr_b16 v[54:55], v209 offset:37888
    s_waitcnt lgkmcnt(8)
    v_mfma_f32_32x32x16_bf16 v[0:15], v[32:35], v[96:99], v[0:15]
    v_mfma_f32_32x32x16_bf16 v[16:31], v[36:39], v[96:99], v[16:31]
    s_bfe_u32 s65, s58, 0x30010
    s_lshl_b32 s65, s65, 17
    s_add_u32 m0, s56, 0x10400
    s_add_u32 s65, s65, 0x4000
    buffer_load_dwordx4 v224, s[8:11], s65 offen lds
    s_bfe_u32 s86, s58, 0x30004
    s_lshl_b32 s86, s86, 12
    s_add_u32 s86, s86, 65536
    buffer_load_dwordx4 v[156:159], v225, s[12:15], s86 offen sc1
    ds_read_b64_tr_b16 v[56:57], v227 offset:38912
    ds_read_b64_tr_b16 v[58:59], v227 offset:39936
    ds_read_b64_tr_b16 v[60:61], v209 offset:38912
    ds_read_b64_tr_b16 v[62:63], v209 offset:39936
    s_waitcnt lgkmcnt(8)
    v_mfma_f32_32x32x16_bf16 v[0:15], v[40:43], v[100:103], v[0:15]
    v_mfma_f32_32x32x16_bf16 v[16:31], v[44:47], v[100:103], v[16:31]
    s_bfe_u32 s65, s58, 0x30014
    s_lshl_b32 s65, s65, 17
    s_add_u32 m0, s56, 0x14000
    s_add_u32 s65, s65, 0x0
    buffer_load_dwordx4 v224, s[8:11], s65 offen lds
    buffer_load_dwordx4 v[160:163], v225, s[12:15], s86 offen offset:1024 sc1
    ds_read_b64_tr_b16 v[32:33], v227 offset:49152
    ds_read_b64_tr_b16 v[34:35], v227 offset:50176
    ds_read_b64_tr_b16 v[36:37], v209 offset:49152
    ds_read_b64_tr_b16 v[38:39], v209 offset:50176
    s_waitcnt lgkmcnt(8)
    v_mfma_f32_32x32x16_bf16 v[0:15], v[48:51], v[104:107], v[0:15]
    v_mfma_f32_32x32x16_bf16 v[16:31], v[52:55], v[104:107], v[16:31]
    s_bfe_u32 s65, s58, 0x30014
    s_lshl_b32 s65, s65, 17
    s_add_u32 m0, s56, 0x14400
    s_add_u32 s65, s65, 0x4000
    buffer_load_dwordx4 v224, s[8:11], s65 offen lds
    buffer_load_dwordx4 v[164:167], v225, s[12:15], s86 offen offset:2048 sc1
    ds_read_b64_tr_b16 v[40:41], v227 offset:51200
    ds_read_b64_tr_b16 v[42:43], v227 offset:52224
    ds_read_b64_tr_b16 v[44:45], v209 offset:51200
    ds_read_b64_tr_b16 v[46:47], v209 offset:52224
    s_waitcnt lgkmcnt(8)
    v_mfma_f32_32x32x16_bf16 v[0:15], v[56:59], v[108:111], v[0:15]
    v_mfma_f32_32x32x16_bf16 v[16:31], v[60:63], v[108:111], v[16:31]
    buffer_load_dwordx4 v[168:171], v225, s[12:15], s86 offen offset:3072 sc1
    ds_read_b64_tr_b16 v[48:49], v227 offset:53248
    ds_read_b64_tr_b16 v[50:51], v227 offset:54272
    ds_read_b64_tr_b16 v[52:53], v209 offset:53248
    ds_read_b64_tr_b16 v[54:55], v209 offset:54272
    s_waitcnt lgkmcnt(8)
    v_mfma_f32_32x32x16_bf16 v[0:15], v[32:35], v[112:115], v[0:15]
    v_mfma_f32_32x32x16_bf16 v[16:31], v[36:39], v[112:115], v[16:31]
    s_mov_b32 s65, 0x1318000
    buffer_load_dword v231, v229, s[12:15], s65 offen sc1
    s_bfe_u32 s86, s58, 0x30008
    s_lshl_b32 s86, s86, 12
    s_add_u32 s86, s86, 65536
    buffer_load_dwordx4 v[172:175], v225, s[12:15], s86 offen sc1
    ds_read_b64_tr_b16 v[56:57], v227 offset:55296
    ds_read_b64_tr_b16 v[58:59], v227 offset:56320
    ds_read_b64_tr_b16 v[60:61], v209 offset:55296
    ds_read_b64_tr_b16 v[62:63], v209 offset:56320
    s_waitcnt lgkmcnt(8)
    v_mfma_f32_32x32x16_bf16 v[0:15], v[40:43], v[116:119], v[0:15]
    v_mfma_f32_32x32x16_bf16 v[16:31], v[44:47], v[116:119], v[16:31]
    buffer_load_dwordx4 v[176:179], v225, s[12:15], s86 offen offset:1024 sc1
    ds_read_b64_tr_b16 v[32:33], v226 offset:0
    ds_read_b64_tr_b16 v[34:35], v226 offset:1024
    ds_read_b64_tr_b16 v[36:37], v208 offset:0
    ds_read_b64_tr_b16 v[38:39], v208 offset:1024
    s_waitcnt lgkmcnt(8)
    v_mfma_f32_32x32x16_bf16 v[0:15], v[48:51], v[120:123], v[0:15]
    v_mfma_f32_32x32x16_bf16 v[16:31], v[52:55], v[120:123], v[16:31]
    buffer_load_dwordx4 v[180:183], v225, s[12:15], s86 offen offset:2048 sc1
    ds_read_b64_tr_b16 v[40:41], v226 offset:2048
    ds_read_b64_tr_b16 v[42:43], v226 offset:3072
    ds_read_b64_tr_b16 v[44:45], v208 offset:2048
    ds_read_b64_tr_b16 v[46:47], v208 offset:3072
    s_waitcnt lgkmcnt(8)
    v_mfma_f32_32x32x16_bf16 v[0:15], v[56:59], v[124:127], v[0:15]
    v_mfma_f32_32x32x16_bf16 v[16:31], v[60:63], v[124:127], v[16:31]
    s_waitcnt vmcnt(16)
    s_barrier
    s_bfe_u32 s65, s58, 0x30018
    s_lshl_b32 s65, s65, 17
    s_add_u32 m0, s56, 0x18000
    s_add_u32 s65, s65, 0x0
    buffer_load_dwordx4 v224, s[8:11], s65 offen lds
    buffer_load_dwordx4 v[184:187], v225, s[12:15], s86 offen offset:3072 sc1
    s_waitcnt vmcnt(5)
    v_cmp_ne_u32 vcc, 1, v231
    s_and_b32 s67, vcc_lo, s60
    s_cbranch_scc0 L_flagok_70
    s_mov_b32 s71, 0
    s_mov_b32 s68, 0x1318000
L_poll_71:
    buffer_load_dword v231, v229, s[12:15], s68 offen sc1
    s_waitcnt vmcnt(0)
    v_cmp_ne_u32 vcc, 1, v231
    s_and_b32 s67, vcc_lo, s60
    s_cbranch_scc0 L_flagok_70
    s_add_u32 s71, s71, 1
    s_cmp_ge_u32 s71, 0x10000
    s_cbranch_scc1 L_flagok_70
    s_sleep 1
    s_branch L_poll_71
L_flagok_70:
    ds_read_b64_tr_b16 v[48:49], v226 offset:4096
    ds_read_b64_tr_b16 v[50:51], v226 offset:5120
    ds_read_b64_tr_b16 v[52:53], v208 offset:4096
    ds_read_b64_tr_b16 v[54:55], v208 offset:5120
    s_waitcnt lgkmcnt(8)
    v_mfma_f32_32x32x16_bf16 v[0:15], v[32:35], v[140:143], v[0:15]
    v_mfma_f32_32x32x16_bf16 v[16:31], v[36:39], v[140:143], v[16:31]
    s_bfe_u32 s65, s58, 0x30018
    s_lshl_b32 s65, s65, 17
    s_add_u32 m0, s56, 0x18400
    s_add_u32 s65, s65, 0x4000
    buffer_load_dwordx4 v224, s[8:11], s65 offen lds
    s_bfe_u32 s86, s58, 0x3000c
    s_lshl_b32 s86, s86, 12
    s_add_u32 s86, s86, 65536
    buffer_load_dwordx4 v[188:191], v225, s[12:15], s86 offen sc1
    ds_read_b64_tr_b16 v[56:57], v226 offset:6144
    ds_read_b64_tr_b16 v[58:59], v226 offset:7168
    ds_read_b64_tr_b16 v[60:61], v208 offset:6144
    ds_read_b64_tr_b16 v[62:63], v208 offset:7168
    s_waitcnt lgkmcnt(8)
    v_mfma_f32_32x32x16_bf16 v[0:15], v[40:43], v[144:147], v[0:15]
    v_mfma_f32_32x32x16_bf16 v[16:31], v[44:47], v[144:147], v[16:31]
    s_bfe_u32 s65, s58, 0x3001c
    s_lshl_b32 s65, s65, 17
    s_add_u32 m0, s56, 0x1c000
    s_add_u32 s65, s65, 0x0
    buffer_load_dwordx4 v224, s[8:11], s65 offen lds
    buffer_load_dwordx4 v[192:195], v225, s[12:15], s86 offen offset:1024 sc1
    ds_read_b64_tr_b16 v[32:33], v226 offset:16384
    ds_read_b64_tr_b16 v[34:35], v226 offset:17408
    ds_read_b64_tr_b16 v[36:37], v208 offset:16384
    ds_read_b64_tr_b16 v[38:39], v208 offset:17408
    s_waitcnt lgkmcnt(8)
    v_mfma_f32_32x32x16_bf16 v[0:15], v[48:51], v[148:151], v[0:15]
    v_mfma_f32_32x32x16_bf16 v[16:31], v[52:55], v[148:151], v[16:31]
    s_bfe_u32 s65, s58, 0x3001c
    s_lshl_b32 s65, s65, 17
    s_add_u32 m0, s56, 0x1c400
    s_add_u32 s65, s65, 0x4000
    buffer_load_dwordx4 v224, s[8:11], s65 offen lds
    buffer_load_dwordx4 v[196:199], v225, s[12:15], s86 offen offset:2048 sc1
    ds_read_b64_tr_b16 v[40:41], v226 offset:18432
    ds_read_b64_tr_b16 v[42:43], v226 offset:19456
    ds_read_b64_tr_b16 v[44:45], v208 offset:18432
    ds_read_b64_tr_b16 v[46:47], v208 offset:19456
    s_waitcnt lgkmcnt(8)
    v_mfma_f32_32x32x16_bf16 v[0:15], v[56:59], v[152:155], v[0:15]
    v_mfma_f32_32x32x16_bf16 v[16:31], v[60:63], v[152:155], v[16:31]
    buffer_load_dwordx4 v[200:203], v225, s[12:15], s86 offen offset:3072 sc1
    ds_read_b64_tr_b16 v[48:49], v226 offset:20480
    ds_read_b64_tr_b16 v[50:51], v226 offset:21504
    ds_read_b64_tr_b16 v[52:53], v208 offset:20480
    ds_read_b64_tr_b16 v[54:55], v208 offset:21504
    s_waitcnt lgkmcnt(8)
    v_mfma_f32_32x32x16_bf16 v[0:15], v[32:35], v[156:159], v[0:15]
    v_mfma_f32_32x32x16_bf16 v[16:31], v[36:39], v[156:159], v[16:31]
    s_bfe_u32 s86, s58, 0x30010
    s_lshl_b32 s86, s86, 12
    s_add_u32 s86, s86, 65536
    buffer_load_dwordx4 v[64:67], v225, s[12:15], s86 offen sc1
    ds_read_b64_tr_b16 v[56:57], v226 offset:22528
    ds_read_b64_tr_b16 v[58:59], v226 offset:23552
    ds_read_b64_tr_b16 v[60:61], v208 offset:22528
    ds_read_b64_tr_b16 v[62:63], v208 offset:23552
    s_waitcnt lgkmcnt(8)
    v_mfma_f32_32x32x16_bf16 v[0:15], v[40:43], v[160:163], v[0:15]
    v_mfma_f32_32x32x16_bf16 v[16:31], v[44:47], v[160:163], v[16:31]
    buffer_load_dwordx4 v[68:71], v225, s[12:15], s86 offen offset:1024 sc1
    ds_read_b64_tr_b16 v[32:33], v226 offset:32768
    ds_read_b64_tr_b16 v[34:35], v226 offset:33792
    ds_read_b64_tr_b16 v[36:37], v208 offset:32768
    ds_read_b64_tr_b16 v[38:39], v208 offset:33792
    s_waitcnt lgkmcnt(8)
    v_mfma_f32_32x32x16_bf16 v[0:15], v[48:51], v[164:167], v[0:15]
    v_mfma_f32_32x32x16_bf16 v[16:31], v[52:55], v[164:167], v[16:31]
    buffer_load_dwordx4 v[72:75], v225, s[12:15], s86 offen offset:2048 sc1
    ds_read_b64_tr_b16 v[40:41], v226 offset:34816
    ds_read_b64_tr_b16 v[42:43], v226 offset:35840
    ds_read_b64_tr_b16 v[44:45], v208 offset:34816
    ds_read_b64_tr_b16 v[46:47], v208 offset:35840
    s_waitcnt lgkmcnt(8)
    v_mfma_f32_32x32x16_bf16 v[0:15], v[56:59], v[168:171], v[0:15]
    v_mfma_f32_32x32x16_bf16 v[16:31], v[60:63], v[168:171], v[16:31]
    s_barrier
    buffer_load_dwordx4 v[76:79], v225, s[12:15], s86 offen offset:3072 sc1
    ds_read_b64_tr_b16 v[48:49], v226 offset:36864
    ds_read_b64_tr_b16 v[50:51], v226 offset:37888
    ds_read_b64_tr_b16 v[52:53], v208 offset:36864
    ds_read_b64_tr_b16 v[54:55], v208 offset:37888
    s_waitcnt lgkmcnt(8)
    s_waitcnt vmcnt(15)
    v_mfma_f32_32x32x16_bf16 v[0:15], v[32:35], v[172:175], v[0:15]
    v_mfma_f32_32x32x16_bf16 v[16:31], v[36:39], v[172:175], v[16:31]
    s_bfe_u32 s86, s58, 0x30014
    s_lshl_b32 s86, s86, 12
    s_add_u32 s86, s86, 65536
    buffer_load_dwordx4 v[80:83], v225, s[12:15], s86 offen sc1
    ds_read_b64_tr_b16 v[56:57], v226 offset:38912
    ds_read_b64_tr_b16 v[58:59], v226 offset:39936
    ds_read_b64_tr_b16 v[60:61], v208 offset:38912
    ds_read_b64_tr_b16 v[62:63], v208 offset:39936
    s_waitcnt lgkmcnt(8)
    s_waitcnt vmcnt(15)
    v_mfma_f32_32x32x16_bf16 v[0:15], v[40:43], v[176:179], v[0:15]
    v_mfma_f32_32x32x16_bf16 v[16:31], v[44:47], v[176:179], v[16:31]
    buffer_load_dwordx4 v[84:87], v225, s[12:15], s86 offen offset:1024 sc1
    ds_read_b64_tr_b16 v[32:33], v226 offset:49152
    ds_read_b64_tr_b16 v[34:35], v226 offset:50176
    ds_read_b64_tr_b16 v[36:37], v208 offset:49152
    ds_read_b64_tr_b16 v[38:39], v208 offset:50176
    s_waitcnt lgkmcnt(8)
    s_waitcnt vmcnt(15)
    v_mfma_f32_32x32x16_bf16 v[0:15], v[48:51], v[180:183], v[0:15]
    v_mfma_f32_32x32x16_bf16 v[16:31], v[52:55], v[180:183], v[16:31]
    buffer_load_dwordx4 v[88:91], v225, s[12:15], s86 offen offset:2048 sc1
    ds_read_b64_tr_b16 v[40:41], v226 offset:51200
    ds_read_b64_tr_b16 v[42:43], v226 offset:52224
    ds_read_b64_tr_b16 v[44:45], v208 offset:51200
    ds_read_b64_tr_b16 v[46:47], v208 offset:52224
    s_waitcnt lgkmcnt(8)
    s_waitcnt vmcnt(14)
    v_mfma_f32_32x32x16_bf16 v[0:15], v[56:59], v[184:187], v[0:15]
    v_mfma_f32_32x32x16_bf16 v[16:31], v[60:63], v[184:187], v[16:31]
    buffer_load_dwordx4 v[92:95], v225, s[12:15], s86 offen offset:3072 sc1
    ds_read_b64_tr_b16 v[48:49], v226 offset:53248
    ds_read_b64_tr_b16 v[50:51], v226 offset:54272
    ds_read_b64_tr_b16 v[52:53], v208 offset:53248
    ds_read_b64_tr_b16 v[54:55], v208 offset:54272
    s_waitcnt lgkmcnt(8)
    s_waitcnt vmcnt(13)
    v_mfma_f32_32x32x16_bf16 v[0:15], v[32:35], v[188:191], v[0:15]
    v_mfma_f32_32x32x16_bf16 v[16:31], v[36:39], v[188:191], v[16:31]
    s_bfe_u32 s86, s58, 0x30018
    s_lshl_b32 s86, s86, 12
    s_add_u32 s86, s86, 65536
    buffer_load_dwordx4 v[96:99], v225, s[12:15], s86 offen sc1
    ds_read_b64_tr_b16 v[56:57], v226 offset:55296
    ds_read_b64_tr_b16 v[58:59], v226 offset:56320
    ds_read_b64_tr_b16 v[60:61], v208 offset:55296
    ds_read_b64_tr_b16 v[62:63], v208 offset:56320
    s_waitcnt lgkmcnt(8)
    s_waitcnt vmcnt(12)
    v_mfma_f32_32x32x16_bf16 v[0:15], v[40:43], v[192:195], v[0:15]
    v_mfma_f32_32x32x16_bf16 v[16:31], v[44:47], v[192:195], v[16:31]
    buffer_load_dwordx4 v[100:103], v225, s[12:15], s86 offen offset:1024 sc1
    ds_read_b64_tr_b16 v[32:33], v227 offset:0
    ds_read_b64_tr_b16 v[34:35], v227 offset:1024
    ds_read_b64_tr_b16 v[36:37], v209 offset:0
    ds_read_b64_tr_b16 v[38:39], v209 offset:1024
    s_waitcnt lgkmcnt(8)
    s_waitcnt vmcnt(11)
    v_mfma_f32_32x32x16_bf16 v[0:15], v[48:51], v[196:199], v[0:15]
    v_mfma_f32_32x32x16_bf16 v[16:31], v[52:55], v[196:199], v[16:31]
    buffer_load_dwordx4 v[104:107], v225, s[12:15], s86 offen offset:2048 sc1
    ds_read_b64_tr_b16 v[40:41], v227 offset:2048
    ds_read_b64_tr_b16 v[42:43], v227 offset:3072
    ds_read_b64_tr_b16 v[44:45], v209 offset:2048
    ds_read_b64_tr_b16 v[46:47], v209 offset:3072
    s_waitcnt lgkmcnt(8)
    s_waitcnt vmcnt(11)
    v_mfma_f32_32x32x16_bf16 v[0:15], v[56:59], v[200:203], v[0:15]
    v_mfma_f32_32x32x16_bf16 v[16:31], v[60:63], v[200:203], v[16:31]
    s_barrier
    buffer_load_dwordx4 v[108:111], v225, s[12:15], s86 offen offset:3072 sc1
    ds_read_b64_tr_b16 v[48:49], v227 offset:4096
    ds_read_b64_tr_b16 v[50:51], v227 offset:5120
    ds_read_b64_tr_b16 v[52:53], v209 offset:4096
    ds_read_b64_tr_b16 v[54:55], v209 offset:5120
    s_waitcnt lgkmcnt(8)
    s_waitcnt vmcnt(11)
    v_mfma_f32_32x32x16_bf16 v[0:15], v[32:35], v[64:67], v[0:15]
    v_mfma_f32_32x32x16_bf16 v[16:31], v[36:39], v[64:67], v[16:31]
    s_bfe_u32 s86, s58, 0x3001c
    s_lshl_b32 s86, s86, 12
    s_add_u32 s86, s86, 65536
    buffer_load_dwordx4 v[112:115], v225, s[12:15], s86 offen sc1
    ds_read_b64_tr_b16 v[56:57], v227 offset:6144
    ds_read_b64_tr_b16 v[58:59], v227 offset:7168
    ds_read_b64_tr_b16 v[60:61], v209 offset:6144
    ds_read_b64_tr_b16 v[62:63], v209 offset:7168
    s_waitcnt lgkmcnt(8)
    s_waitcnt vmcnt(11)
    v_mfma_f32_32x32x16_bf16 v[0:15], v[40:43], v[68:71], v[0:15]
    v_mfma_f32_32x32x16_bf16 v[16:31], v[44:47], v[68:71], v[16:31]
    buffer_load_dwordx4 v[116:119], v225, s[12:15], s86 offen offset:1024 sc1
    ds_read_b64_tr_b16 v[32:33], v209 offset:16384
    ds_read_b64_tr_b16 v[34:35], v209 offset:17408
    ds_read_b64_tr_b16 v[36:37], v209 offset:18432
    ds_read_b64_tr_b16 v[38:39], v209 offset:19456
    s_waitcnt lgkmcnt(8)
    s_waitcnt vmcnt(11)
    v_mfma_f32_32x32x16_bf16 v[0:15], v[48:51], v[72:75], v[0:15]
    v_mfma_f32_32x32x16_bf16 v[16:31], v[52:55], v[72:75], v[16:31]
    buffer_load_dwordx4 v[120:123], v225, s[12:15], s86 offen offset:2048 sc1
    ds_read_b64_tr_b16 v[40:41], v209 offset:20480
    ds_read_b64_tr_b16 v[42:43], v209 offset:21504
    ds_read_b64_tr_b16 v[44:45], v209 offset:22528
    ds_read_b64_tr_b16 v[46:47], v209 offset:23552
    s_waitcnt lgkmcnt(8)
    s_waitcnt vmcnt(11)
    v_mfma_f32_32x32x16_bf16 v[0:15], v[56:59], v[76:79], v[0:15]
    v_mfma_f32_32x32x16_bf16 v[16:31], v[60:63], v[76:79], v[16:31]
    buffer_load_dwordx4 v[124:127], v225, s[12:15], s86 offen offset:3072 sc1
    s_lshl_b32 s64, s48, 12
    s_add_u32 s64, s64, 0x0
    v_add_u32 v232, s64, v254
    s_xor_b32 s65, s48, 4
    s_lshl_b32 s64, s65, 12
    s_add_u32 s64, s64, 0x0
    v_add_u32 v233, s64, v254
    s_lshl_b32 s64, s81, 7
    s_and_b32 s65, s48, 3
    s_lshl_b32 s65, s65, 5
    s_add_u32 s64, s64, s65
    v_and_b32 v234, 31, v253
    v_add_u32 v234, s64, v234
    v_lshlrev_b32 v234, 11, v234
    v_lshl_add_u32 v234, v255, 4, v234
    s_lshl_b32 s64, s82, 7
    s_lshl_b32 s65, s49, 6
    s_add_u32 s64, s64, s65
    v_add_u32 v234, s64, v234
    ds_read_b64_tr_b16 v[48:49], v209 offset:32768
    ds_read_b64_tr_b16 v[50:51], v209 offset:33792
    s_waitcnt lgkmcnt(8)
    s_waitcnt vmcnt(11)
    v_mfma_f32_32x32x16_bf16 v[16:31], v[32:35], v[80:83], v[16:31]
    ds_read_b64_tr_b16 v[52:53], v209 offset:34816
    ds_read_b64_tr_b16 v[54:55], v209 offset:35840
    s_waitcnt lgkmcnt(8)
    s_waitcnt vmcnt(10)
    v_mfma_f32_32x32x16_bf16 v[16:31], v[36:39], v[84:87], v[16:31]
    ds_read_b64_tr_b16 v[56:57], v209 offset:36864
    ds_read_b64_tr_b16 v[58:59], v209 offset:37888
    s_waitcnt lgkmcnt(8)
    s_waitcnt vmcnt(9)
    v_mfma_f32_32x32x16_bf16 v[16:31], v[40:43], v[88:91], v[16:31]
    ds_read_b64_tr_b16 v[60:61], v209 offset:38912
    ds_read_b64_tr_b16 v[62:63], v209 offset:39936
    s_waitcnt lgkmcnt(8)
    s_waitcnt vmcnt(8)
    v_mfma_f32_32x32x16_bf16 v[16:31], v[44:47], v[92:95], v[16:31]
    ds_read_b64_tr_b16 v[32:33], v209 offset:49152
    ds_read_b64_tr_b16 v[34:35], v209 offset:50176
    s_waitcnt lgkmcnt(8)
    s_waitcnt vmcnt(7)
    v_mfma_f32_32x32x16_bf16 v[16:31], v[48:51], v[96:99], v[16:31]
    ds_read_b64_tr_b16 v[36:37], v209 offset:51200
    ds_read_b64_tr_b16 v[38:39], v209 offset:52224
    s_waitcnt lgkmcnt(8)
    s_waitcnt vmcnt(6)
    v_mfma_f32_32x32x16_bf16 v[16:31], v[52:55], v[100:103], v[16:31]
    ds_read_b64_tr_b16 v[40:41], v209 offset:53248
    ds_read_b64_tr_b16 v[42:43], v209 offset:54272
    s_waitcnt lgkmcnt(8)
    s_waitcnt vmcnt(5)
    v_mfma_f32_32x32x16_bf16 v[16:31], v[56:59], v[104:107], v[16:31]
    ds_read_b64_tr_b16 v[44:45], v209 offset:55296
    ds_read_b64_tr_b16 v[46:47], v209 offset:56320
    s_waitcnt lgkmcnt(8)
    s_waitcnt vmcnt(4)
    v_mfma_f32_32x32x16_bf16 v[16:31], v[60:63], v[108:111], v[16:31]
    ds_read_b64_tr_b16 v[48:49], v227 offset:16384
    ds_read_b64_tr_b16 v[50:51], v227 offset:17408
    s_waitcnt lgkmcnt(8)
    s_waitcnt vmcnt(3)
    v_mfma_f32_32x32x16_bf16 v[16:31], v[32:35], v[112:115], v[16:31]
    ds_read_b64_tr_b16 v[52:53], v227 offset:18432
    ds_read_b64_tr_b16 v[54:55], v227 offset:19456
    s_waitcnt lgkmcnt(8)
    s_waitcnt vmcnt(2)
    v_mfma_f32_32x32x16_bf16 v[16:31], v[36:39], v[116:119], v[16:31]
    ds_read_b64_tr_b16 v[56:57], v227 offset:20480
    ds_read_b64_tr_b16 v[58:59], v227 offset:21504
    s_waitcnt lgkmcnt(8)
    s_waitcnt vmcnt(1)
    v_mfma_f32_32x32x16_bf16 v[16:31], v[40:43], v[120:123], v[16:31]
    ds_read_b64_tr_b16 v[60:61], v227 offset:22528
    ds_read_b64_tr_b16 v[62:63], v227 offset:23552
    s_waitcnt lgkmcnt(8)
    s_waitcnt vmcnt(0)
    v_mfma_f32_32x32x16_bf16 v[16:31], v[44:47], v[124:127], v[16:31]
    ds_read_b64_tr_b16 v[32:33], v227 offset:32768
    ds_read_b64_tr_b16 v[34:35], v227 offset:33792
    s_waitcnt lgkmcnt(8)
    v_mfma_f32_32x32x16_bf16 v[0:15], v[48:51], v[80:83], v[0:15]
    ds_read_b64_tr_b16 v[36:37], v227 offset:34816
    ds_read_b64_tr_b16 v[38:39], v227 offset:35840
    s_waitcnt lgkmcnt(8)
    v_mfma_f32_32x32x16_bf16 v[0:15], v[52:55], v[84:87], v[0:15]
    ds_read_b64_tr_b16 v[40:41], v227 offset:36864
    ds_read_b64_tr_b16 v[42:43], v227 offset:37888
    s_waitcnt lgkmcnt(8)
    v_mfma_f32_32x32x16_bf16 v[0:15], v[56:59], v[88:91], v[0:15]
    ds_write_b128 v232, v[16:19] offset:0
    ds_read_b64_tr_b16 v[44:45], v227 offset:38912
    ds_read_b64_tr_b16 v[46:47], v227 offset:39936
    s_waitcnt lgkmcnt(9)
    v_mfma_f32_32x32x16_bf16 v[0:15], v[60:63], v[92:95], v[0:15]
    ds_write_b128 v232, v[20:23] offset:1024
    ds_read_b64_tr_b16 v[48:49], v227 offset:49152
    ds_read_b64_tr_b16 v[50:51], v227 offset:50176
    s_waitcnt lgkmcnt(10)
    v_mfma_f32_32x32x16_bf16 v[0:15], v[32:35], v[96:99], v[0:15]
    ds_write_b128 v232, v[24:27] offset:2048
    ds_read_b64_tr_b16 v[52:53], v227 offset:51200
    ds_read_b64_tr_b16 v[54:55], v227 offset:52224
    s_waitcnt lgkmcnt(11)
    v_mfma_f32_32x32x16_bf16 v[0:15], v[36:39], v[100:103], v[0:15]
    ds_write_b128 v232, v[28:31] offset:3072
    ds_read_b64_tr_b16 v[56:57], v227 offset:53248
    ds_read_b64_tr_b16 v[58:59], v227 offset:54272
    s_waitcnt lgkmcnt(12)
    v_mfma_f32_32x32x16_bf16 v[0:15], v[40:43], v[104:107], v[0:15]
    ds_read_b64_tr_b16 v[60:61], v227 offset:55296
    ds_read_b64_tr_b16 v[62:63], v227 offset:56320
    s_waitcnt lgkmcnt(11)
    v_mfma_f32_32x32x16_bf16 v[0:15], v[44:47], v[108:111], v[0:15]
    s_waitcnt lgkmcnt(4)
    s_barrier
    ds_read_b128 v[140:143], v233 offset:0
    ds_read_b128 v[144:147], v233 offset:1024
    ds_read_b128 v[148:151], v233 offset:2048
    ds_read_b128 v[152:155], v233 offset:3072
    s_waitcnt lgkmcnt(12)
    v_mfma_f32_32x32x16_bf16 v[0:15], v[48:51], v[112:115], v[0:15]
    s_waitcnt lgkmcnt(9)
    v_mfma_f32_32x32x16_bf16 v[0:15], v[52:55], v[116:119], v[0:15]
    s_waitcnt lgkmcnt(6)
    v_mfma_f32_32x32x16_bf16 v[0:15], v[56:59], v[120:123], v[0:15]
    s_waitcnt lgkmcnt(4)
    v_mfma_f32_32x32x16_bf16 v[0:15], v[60:63], v[124:127], v[0:15]
    s_waitcnt lgkmcnt(0)
    s_nop 10
    v_add_f32 v0, v0, v140
    v_add_f32 v1, v1, v141
    v_add_f32 v2, v2, v142
    v_add_f32 v3, v3, v143
    v_add_f32 v4, v4, v144
    v_add_f32 v5, v5, v145
    v_add_f32 v6, v6, v146
    v_add_f32 v7, v7, v147
    v_add_f32 v8, v8, v148
    v_add_f32 v9, v9, v149
    v_add_f32 v10, v10, v150
    v_add_f32 v11, v11, v151
    v_add_f32 v12, v12, v152
    v_add_f32 v13, v13, v153
    v_add_f32 v14, v14, v154
    v_add_f32 v15, v15, v155
    v_cvt_pk_bf16_f32 v48, v0, v1
    v_cvt_pk_bf16_f32 v49, v2, v3
    v_cvt_pk_bf16_f32 v50, v4, v5
    v_cvt_pk_bf16_f32 v51, v6, v7
    v_cvt_pk_bf16_f32 v52, v8, v9
    v_cvt_pk_bf16_f32 v53, v10, v11
    v_cvt_pk_bf16_f32 v54, v12, v13
    v_cvt_pk_bf16_f32 v55, v14, v15
    v_permlane32_swap_b32 v48, v50
    v_permlane32_swap_b32 v49, v51
    v_permlane32_swap_b32 v52, v54
    v_permlane32_swap_b32 v53, v55
    buffer_store_dwordx4 v[48:51], v234, s[16:19], 0 offen
    buffer_store_dwordx4 v[52:55], v234, s[16:19], 0 offen offset:32
    s_waitcnt vmcnt(0) lgkmcnt(0)
    s_waitcnt vmcnt(0) lgkmcnt(0)
L_end:
    s_endpgm
L_retry:
    s_waitcnt vmcnt(0)
    v_mov_b32 v205, 0xff800000
    v_mov_b32 v206, 0xff800000
    s_mov_b32 s73, 0
L_truemax:
    s_add_u32 s64, s73, s74
    s_and_b32 s64, s64, 31
    s_lshl_b32 s64, s64, 12
    s_cmp_ge_u32 s73, 32
    s_cselect_b32 s64, 0x7000000, s64
    buffer_load_dwordx4 v[140:143], v204, s[12:15], s64 offen sc1
    buffer_load_dwordx4 v[144:147], v204, s[12:15], s64 offen offset:1024 sc1
    s_waitcnt vmcnt(0)
    v_mfma_f32_32x32x16_bf16 v[0:15], v[140:143], v[96:99], 0
    v_mfma_f32_32x32x16_bf16 v[16:31], v[140:143], v[104:107], 0
    v_mfma_f32_32x32x16_bf16 v[0:15], v[144:147], v[100:103], v[0:15]
    v_mfma_f32_32x32x16_bf16 v[16:31], v[144:147], v[108:111], v[16:31]
    s_nop 10
    v_max3_f32 v205, v205, v0, v1
    v_max3_f32 v205, v205, v2, v3
    v_max3_f32 v205, v205, v4, v5
    v_max3_f32 v205, v205, v6, v7
    v_max3_f32 v205, v205, v8, v9
    v_max3_f32 v205, v205, v10, v11
    v_max3_f32 v205, v205, v12, v13
    v_max3_f32 v205, v205, v14, v15
    v_max3_f32 v206, v206, v16, v17
    v_max3_f32 v206, v206, v18, v19
    v_max3_f32 v206, v206, v20, v21
    v_max3_f32 v206, v206, v22, v23
    v_max3_f32 v206, v206, v24, v25
    v_max3_f32 v206, v206, v26, v27
    v_max3_f32 v206, v206, v28, v29
    v_max3_f32 v206, v206, v30, v31
    s_add_u32 s73, s73, 1
    s_cmp_lt_u32 s73, 32
    s_cbranch_scc1 L_truemax
    v_mov_b32 v207, v205
    s_nop 1
    v_permlane32_swap_b32 v205, v207
    v_max_f32 v205, v205, v207
    v_mov_b32 v207, v206
    s_nop 1
    v_permlane32_swap_b32 v206, v207
    v_max_f32 v206, v206, v207
    s_mov_b32 s73, 0
    s_add_u32 s64, s73, s74
    s_and_b32 s64, s64, 31
    s_lshl_b32 s64, s64, 12
    s_cmp_ge_u32 s73, 32
    s_cselect_b32 s64, 0x7000000, s64
    buffer_load_dwordx4 v[140:143], v204, s[12:15], s64 offen sc1
    buffer_load_dwordx4 v[144:147], v204, s[12:15], s64 offen offset:1024 sc1
    buffer_load_dwordx4 v[148:151], v204, s[12:15], s64 offen offset:2048 sc1
    buffer_load_dwordx4 v[152:155], v204, s[12:15], s64 offen offset:3072 sc1
    s_mov_b32 s73, 1
    s_add_u32 s64, s73, s74
    s_and_b32 s64, s64, 31
    s_lshl_b32 s64, s64, 12
    s_cmp_ge_u32 s73, 32
    s_cselect_b32 s64, 0x7000000, s64
    buffer_load_dwordx4 v[156:159], v204, s[12:15], s64 offen sc1
    buffer_load_dwordx4 v[160:163], v204, s[12:15], s64 offen offset:1024 sc1
    buffer_load_dwordx4 v[164:167], v204, s[12:15], s64 offen offset:2048 sc1
    buffer_load_dwordx4 v[168:171], v204, s[12:15], s64 offen offset:3072 sc1
    s_mov_b32 s73, 2
    s_add_u32 s64, s73, s74
    s_and_b32 s64, s64, 31
    s_lshl_b32 s64, s64, 12
    s_cmp_ge_u32 s73, 32
    s_cselect_b32 s64, 0x7000000, s64
    buffer_load_dwordx4 v[172:175], v204, s[12:15], s64 offen sc1
    buffer_load_dwordx4 v[176:179], v204, s[12:15], s64 offen offset:1024 sc1
    buffer_load_dwordx4 v[180:183], v204, s[12:15], s64 offen offset:2048 sc1
    buffer_load_dwordx4 v[184:187], v204, s[12:15], s64 offen offset:3072 sc1
    s_mov_b32 s73, 3
    s_waitcnt vmcnt(10)
    v_mov_b32 v196, 0
    v_mov_b32 v120, 0
    v_mov_b32 v197, 0
    v_mov_b32 v121, 0
    v_mov_b32 v198, 0
    v_mov_b32 v122, 0
    v_mov_b32 v199, 0
    v_mov_b32 v123, 0
    v_mov_b32 v200, 0
    v_mov_b32 v124, 0
    v_mov_b32 v201, 0
    v_mov_b32 v125, 0
    v_mov_b32 v202, 0
    v_mov_b32 v126, 0
    v_mov_b32 v203, 0
    v_mov_b32 v127, 0
    v_mov_b32 v128, 0
    v_mov_b32 v132, 0
    v_mov_b32 v129, 0
    v_mov_b32 v133, 0
    v_mov_b32 v130, 0
    v_mov_b32 v134, 0
    v_mov_b32 v131, 0
    v_mov_b32 v135, 0
    v_sub_f32 v32, 0, v205
    v_sub_f32 v33, 0, v205
    v_sub_f32 v34, 0, v205
    v_sub_f32 v35, 0, v205
    v_sub_f32 v36, 0, v205
    v_sub_f32 v37, 0, v205
    v_sub_f32 v38, 0, v205
    v_sub_f32 v39, 0, v205
    v_sub_f32 v40, 0, v205
    v_sub_f32 v41, 0, v205
    v_sub_f32 v42, 0, v205
    v_sub_f32 v43, 0, v205
    v_sub_f32 v44, 0, v205
    v_sub_f32 v45, 0, v205
    v_sub_f32 v46, 0, v205
    v_sub_f32 v47, 0, v205
    v_mfma_f32_32x32x16_bf16 v[64:79], v[196:199], v[196:199], 0
    v_mfma_f32_32x32x16_bf16 v[80:95], v[196:199], v[196:199], 0
    v_sub_f32 v48, 0, v206
    v_sub_f32 v49, 0, v206
    v_sub_f32 v50, 0, v206
    v_sub_f32 v51, 0, v206
    v_sub_f32 v52, 0, v206
    v_sub_f32 v53, 0, v206
    v_sub_f32 v54, 0, v206
    v_sub_f32 v55, 0, v206
    v_sub_f32 v56, 0, v206
    v_sub_f32 v57, 0, v206
    v_sub_f32 v58, 0, v206
    v_sub_f32 v59, 0, v206
    v_sub_f32 v60, 0, v206
    v_sub_f32 v61, 0, v206
    v_sub_f32 v62, 0, v206
    v_sub_f32 v63, 0, v206
    v_mfma_f32_32x32x16_bf16 v[0:15], v[140:143], v[96:99], v[32:47]
    v_mfma_f32_32x32x16_bf16 v[0:15], v[144:147], v[100:103], v[0:15]
    v_and_b32 v205, 1, v253
    v_mul_u32_u24 v205, 0xaaaa, v205
    v_add_u32 v205, 0x4444, v205
    s_mov_b32 s75, 0
L_retry_loop:
    v_mfma_f32_32x32x16_bf16 v[16:31], v[140:143], v[104:107], v[48:63]
    s_nop 6
    v_exp_f32 v0, v0
    v_exp_f32 v1, v1
    v_exp_f32 v2, v2
    v_exp_f32 v3, v3
    v_mfma_f32_32x32x16_bf16 v[16:31], v[144:147], v[108:111], v[16:31]
    v_cvt_pk_bf16_f32 v112, v0, v1
    v_cvt_pk_bf16_f32 v113, v2, v3
    v_exp_f32 v4, v4
    v_exp_f32 v5, v5
    v_exp_f32 v6, v6
    v_mfma_f32_32x32x16_bf16 v[80:95], v[196:199], v[120:123], v[80:95]
    v_exp_f32 v7, v7
    v_cvt_pk_bf16_f32 v114, v4, v5
    v_cvt_pk_bf16_f32 v115, v6, v7
    v_exp_f32 v8, v8
    v_exp_f32 v9, v9
    v_mfma_f32_32x32x16_bf16 v[80:95], v[200:203], v[124:127], v[80:95]
    v_exp_f32 v10, v10
    v_exp_f32 v11, v11
    v_cvt_pk_bf16_f32 v116, v8, v9
    v_cvt_pk_bf16_f32 v117, v10, v11
    v_exp_f32 v12, v12
    v_smfmac_f32_16x16x64_bf16 v[132:135], v[136:139], v[120:127], v205
    v_exp_f32 v13, v13
    v_exp_f32 v14, v14
    v_exp_f32 v15, v15
    v_cvt_pk_bf16_f32 v118, v12, v13
    v_cvt_pk_bf16_f32 v119, v14, v15
    s_add_u32 s64, s73, s74
    s_and_b32 s64, s64, 31
    s_lshl_b32 s64, s64, 12
    s_cmp_ge_u32 s73, 32
    s_cselect_b32 s64, 0x7000000, s64
    s_add_u32 s73, s73, 1
    s_waitcnt vmcnt(6)
    v_mfma_f32_32x32x16_bf16 v[0:15], v[156:159], v[96:99], v[32:47]
    v_exp_f32 v16, v16
    v_exp_f32 v17, v17
    v_exp_f32 v18, v18
    buffer_load_dwordx4 v[188:191], v204, s[12:15], s64 offen sc1
    v_exp_f32 v19, v19
    v_mfma_f32_32x32x16_bf16 v[0:15], v[160:163], v[100:103], v[0:15]
    v_cvt_pk_bf16_f32 v120, v16, v17
    v_cvt_pk_bf16_f32 v121, v18, v19
    v_exp_f32 v20, v20
    v_exp_f32 v21, v21
    buffer_load_dwordx4 v[192:195], v204, s[12:15], s64 offen offset:1024 sc1
    v_exp_f32 v22, v22
    v_mfma_f32_32x32x16_bf16 v[64:79], v[148:151], v[112:115], v[64:79]
    v_exp_f32 v23, v23
    v_cvt_pk_bf16_f32 v122, v20, v21
    v_cvt_pk_bf16_f32 v123, v22, v23
    v_exp_f32 v24, v24
    buffer_load_dwordx4 v[196:199], v204, s[12:15], s64 offen offset:2048 sc1
    v_exp_f32 v25, v25
    v_mfma_f32_32x32x16_bf16 v[64:79], v[152:155], v[116:119], v[64:79]
    v_exp_f32 v26, v26
    v_exp_f32 v27, v27
    v_cvt_pk_bf16_f32 v124, v24, v25
    v_cvt_pk_bf16_f32 v125, v26, v27
    buffer_load_dwordx4 v[200:203], v204, s[12:15], s64 offen offset:3072 sc1
    v_exp_f32 v28, v28
    v_smfmac_f32_16x16x64_bf16 v[128:131], v[136:139], v[112:119], v205
    v_exp_f32 v29, v29
    v_exp_f32 v30, v30
    v_exp_f32 v31, v31
    v_cvt_pk_bf16_f32 v126, v28, v29
    v_cvt_pk_bf16_f32 v127, v30, v31
    v_mfma_f32_32x32x16_bf16 v[16:31], v[156:159], v[104:107], v[48:63]
    v_exp_f32 v0, v0
    v_exp_f32 v1, v1
    v_exp_f32 v2, v2
    v_exp_f32 v3, v3
    v_mfma_f32_32x32x16_bf16 v[16:31], v[160:163], v[108:111], v[16:31]
    v_cvt_pk_bf16_f32 v112, v0, v1
    v_cvt_pk_bf16_f32 v113, v2, v3
    v_exp_f32 v4, v4
    v_exp_f32 v5, v5
    v_exp_f32 v6, v6
    v_mfma_f32_32x32x16_bf16 v[80:95], v[148:151], v[120:123], v[80:95]
    v_exp_f32 v7, v7
    v_cvt_pk_bf16_f32 v114, v4, v5
    v_cvt_pk_bf16_f32 v115, v6, v7
    v_exp_f32 v8, v8
    v_exp_f32 v9, v9
    v_mfma_f32_32x32x16_bf16 v[80:95], v[152:155], v[124:127], v[80:95]
    v_exp_f32 v10, v10
    v_exp_f32 v11, v11
    v_cvt_pk_bf16_f32 v116, v8, v9
    v_cvt_pk_bf16_f32 v117, v10, v11
    v_exp_f32 v12, v12
    v_smfmac_f32_16x16x64_bf16 v[132:135], v[136:139], v[120:127], v205
    v_exp_f32 v13, v13
    v_exp_f32 v14, v14
    v_exp_f32 v15, v15
    v_cvt_pk_bf16_f32 v118, v12, v13
    v_cvt_pk_bf16_f32 v119, v14, v15
    s_add_u32 s64, s73, s74
    s_and_b32 s64, s64, 31
    s_lshl_b32 s64, s64, 12
    s_cmp_ge_u32 s73, 32
    s_cselect_b32 s64, 0x7000000, s64
    s_add_u32 s73, s73, 1
    s_waitcnt vmcnt(6)
    v_mfma_f32_32x32x16_bf16 v[0:15], v[172:175], v[96:99], v[32:47]
    v_exp_f32 v16, v16
    v_exp_f32 v17, v17
    v_exp_f32 v18, v18
    buffer_load_dwordx4 v[140:143], v204, s[12:15], s64 offen sc1
    v_exp_f32 v19, v19
    v_mfma_f32_32x32x16_bf16 v[0:15], v[176:179], v[100:103], v[0:15]
    v_cvt_pk_bf16_f32 v120, v16, v17
    v_cvt_pk_bf16_f32 v121, v18, v19
    v_exp_f32 v20, v20
    v_exp_f32 v21, v21
    buffer_load_dwordx4 v[144:147], v204, s[12:15], s64 offen offset:1024 sc1
    v_exp_f32 v22, v22
    v_mfma_f32_32x32x16_bf16 v[64:79], v[164:167], v[112:115], v[64:79]
    v_exp_f32 v23, v23
    v_cvt_pk_bf16_f32 v122, v20, v21
    v_cvt_pk_bf16_f32 v123, v22, v23
    v_exp_f32 v24, v24
    buffer_load_dwordx4 v[148:151], v204, s[12:15], s64 offen offset:2048 sc1
    v_exp_f32 v25, v25
    v_mfma_f32_32x32x16_bf16 v[64:79], v[168:171], v[116:119], v[64:79]
    v_exp_f32 v26, v26
    v_exp_f32 v27, v27
    v_cvt_pk_bf16_f32 v124, v24, v25
    v_cvt_pk_bf16_f32 v125, v26, v27
    buffer_load_dwordx4 v[152:155], v204, s[12:15], s64 offen offset:3072 sc1
    v_exp_f32 v28, v28
    v_smfmac_f32_16x16x64_bf16 v[128:131], v[136:139], v[112:119], v205
    v_exp_f32 v29, v29
    v_exp_f32 v30, v30
    v_exp_f32 v31, v31
    v_cvt_pk_bf16_f32 v126, v28, v29
    v_cvt_pk_bf16_f32 v127, v30, v31
    v_mfma_f32_32x32x16_bf16 v[16:31], v[172:175], v[104:107], v[48:63]
    v_exp_f32 v0, v0
    v_exp_f32 v1, v1
    v_exp_f32 v2, v2
    v_exp_f32 v3, v3
    v_mfma_f32_32x32x16_bf16 v[16:31], v[176:179], v[108:111], v[16:31]
    v_cvt_pk_bf16_f32 v112, v0, v1
    v_cvt_pk_bf16_f32 v113, v2, v3
    v_exp_f32 v4, v4
    v_exp_f32 v5, v5
    v_exp_f32 v6, v6
    v_mfma_f32_32x32x16_bf16 v[80:95], v[164:167], v[120:123], v[80:95]
    v_exp_f32 v7, v7
    v_cvt_pk_bf16_f32 v114, v4, v5
    v_cvt_pk_bf16_f32 v115, v6, v7
    v_exp_f32 v8, v8
    v_exp_f32 v9, v9
    v_mfma_f32_32x32x16_bf16 v[80:95], v[168:171], v[124:127], v[80:95]
    v_exp_f32 v10, v10
    v_exp_f32 v11, v11
    v_cvt_pk_bf16_f32 v116, v8, v9
    v_cvt_pk_bf16_f32 v117, v10, v11
    v_exp_f32 v12, v12
    v_smfmac_f32_16x16x64_bf16 v[132:135], v[136:139], v[120:127], v205
    v_exp_f32 v13, v13
    v_exp_f32 v14, v14
    v_exp_f32 v15, v15
    v_cvt_pk_bf16_f32 v118, v12, v13
    v_cvt_pk_bf16_f32 v119, v14, v15
    s_add_u32 s64, s73, s74
    s_and_b32 s64, s64, 31
    s_lshl_b32 s64, s64, 12
    s_cmp_ge_u32 s73, 32
    s_cselect_b32 s64, 0x7000000, s64
    s_add_u32 s73, s73, 1
    s_waitcnt vmcnt(6)
    v_mfma_f32_32x32x16_bf16 v[0:15], v[188:191], v[96:99], v[32:47]
    v_exp_f32 v16, v16
    v_exp_f32 v17, v17
    v_exp_f32 v18, v18
    buffer_load_dwordx4 v[156:159], v204, s[12:15], s64 offen sc1
    v_exp_f32 v19, v19
    v_mfma_f32_32x32x16_bf16 v[0:15], v[192:195], v[100:103], v[0:15]
    v_cvt_pk_bf16_f32 v120, v16, v17
    v_cvt_pk_bf16_f32 v121, v18, v19
    v_exp_f32 v20, v20
    v_exp_f32 v21, v21
    buffer_load_dwordx4 v[160:163], v204, s[12:15], s64 offen offset:1024 sc1
    v_exp_f32 v22, v22
    v_mfma_f32_32x32x16_bf16 v[64:79], v[180:183], v[112:115], v[64:79]
    v_exp_f32 v23, v23
    v_cvt_pk_bf16_f32 v122, v20, v21
    v_cvt_pk_bf16_f32 v123, v22, v23
    v_exp_f32 v24, v24
    buffer_load_dwordx4 v[164:167], v204, s[12:15], s64 offen offset:2048 sc1
    v_exp_f32 v25, v25
    v_mfma_f32_32x32x16_bf16 v[64:79], v[184:187], v[116:119], v[64:79]
    v_exp_f32 v26, v26
    v_exp_f32 v27, v27
    v_cvt_pk_bf16_f32 v124, v24, v25
    v_cvt_pk_bf16_f32 v125, v26, v27
    buffer_load_dwordx4 v[168:171], v204, s[12:15], s64 offen offset:3072 sc1
    v_exp_f32 v28, v28
    v_smfmac_f32_16x16x64_bf16 v[128:131], v[136:139], v[112:119], v205
    v_exp_f32 v29, v29
    v_exp_f32 v30, v30
    v_exp_f32 v31, v31
    v_cvt_pk_bf16_f32 v126, v28, v29
    v_cvt_pk_bf16_f32 v127, v30, v31
    v_mfma_f32_32x32x16_bf16 v[16:31], v[188:191], v[104:107], v[48:63]
    v_exp_f32 v0, v0
    v_exp_f32 v1, v1
    v_exp_f32 v2, v2
    v_exp_f32 v3, v3
    v_mfma_f32_32x32x16_bf16 v[16:31], v[192:195], v[108:111], v[16:31]
    v_cvt_pk_bf16_f32 v112, v0, v1
    v_cvt_pk_bf16_f32 v113, v2, v3
    v_exp_f32 v4, v4
    v_exp_f32 v5, v5
    v_exp_f32 v6, v6
    v_mfma_f32_32x32x16_bf16 v[80:95], v[180:183], v[120:123], v[80:95]
    v_exp_f32 v7, v7
    v_cvt_pk_bf16_f32 v114, v4, v5
    v_cvt_pk_bf16_f32 v115, v6, v7
    v_exp_f32 v8, v8
    v_exp_f32 v9, v9
    v_mfma_f32_32x32x16_bf16 v[80:95], v[184:187], v[124:127], v[80:95]
    v_exp_f32 v10, v10
    v_exp_f32 v11, v11
    v_cvt_pk_bf16_f32 v116, v8, v9
    v_cvt_pk_bf16_f32 v117, v10, v11
    v_exp_f32 v12, v12
    v_smfmac_f32_16x16x64_bf16 v[132:135], v[136:139], v[120:127], v205
    v_exp_f32 v13, v13
    v_exp_f32 v14, v14
    v_exp_f32 v15, v15
    v_cvt_pk_bf16_f32 v118, v12, v13
    v_cvt_pk_bf16_f32 v119, v14, v15
    s_add_u32 s64, s73, s74
    s_and_b32 s64, s64, 31
    s_lshl_b32 s64, s64, 12
    s_cmp_ge_u32 s73, 32
    s_cselect_b32 s64, 0x7000000, s64
    s_add_u32 s73, s73, 1
    s_waitcnt vmcnt(6)
    v_mfma_f32_32x32x16_bf16 v[0:15], v[140:143], v[96:99], v[32:47]
    v_exp_f32 v16, v16
    v_exp_f32 v17, v17
    v_exp_f32 v18, v18
    buffer_load_dwordx4 v[172:175], v204, s[12:15], s64 offen sc1
    v_exp_f32 v19, v19
    v_mfma_f32_32x32x16_bf16 v[0:15], v[144:147], v[100:103], v[0:15]
    v_cvt_pk_bf16_f32 v120, v16, v17
    v_cvt_pk_bf16_f32 v121, v18, v19
    v_exp_f32 v20, v20
    v_exp_f32 v21, v21
    buffer_load_dwordx4 v[176:179], v204, s[12:15], s64 offen offset:1024 sc1
    v_exp_f32 v22, v22
    v_mfma_f32_32x32x16_bf16 v[64:79], v[196:199], v[112:115], v[64:79]
    v_exp_f32 v23, v23
    v_cvt_pk_bf16_f32 v122, v20, v21
    v_cvt_pk_bf16_f32 v123, v22, v23
    v_exp_f32 v24, v24
    buffer_load_dwordx4 v[180:183], v204, s[12:15], s64 offen offset:2048 sc1
    v_exp_f32 v25, v25
    v_mfma_f32_32x32x16_bf16 v[64:79], v[200:203], v[116:119], v[64:79]
    v_exp_f32 v26, v26
    v_exp_f32 v27, v27
    v_cvt_pk_bf16_f32 v124, v24, v25
    v_cvt_pk_bf16_f32 v125, v26, v27
    buffer_load_dwordx4 v[184:187], v204, s[12:15], s64 offen offset:3072 sc1
    v_exp_f32 v28, v28
    v_smfmac_f32_16x16x64_bf16 v[128:131], v[136:139], v[112:119], v205
    v_exp_f32 v29, v29
    v_exp_f32 v30, v30
    v_exp_f32 v31, v31
    v_cvt_pk_bf16_f32 v126, v28, v29
    v_cvt_pk_bf16_f32 v127, v30, v31
    s_add_u32 s75, s75, 1
    s_cmp_lt_u32 s75, 8
    s_cbranch_scc1 L_retry_loop
    v_mfma_f32_32x32x16_bf16 v[80:95], v[196:199], v[120:123], v[80:95]
    v_mfma_f32_32x32x16_bf16 v[80:95], v[200:203], v[124:127], v[80:95]
    v_smfmac_f32_16x16x64_bf16 v[132:135], v[136:139], v[120:127], v205
    s_nop 0
    v_add_f32 v128, v128, v129
    s_nop 9
    v_add_f32 v132, v132, v133
    s_waitcnt vmcnt(0)
    s_add_u32 s86, s85, 0
    s_and_b32 s86, s86, 7
    s_lshl_b32 s86, s86, 12
    buffer_load_dwordx4 v[140:143], v225, s[12:15], s86 offen sc1
    buffer_load_dwordx4 v[144:147], v225, s[12:15], s86 offen offset:1024 sc1
    buffer_load_dwordx4 v[148:151], v225, s[12:15], s86 offen offset:2048 sc1
    buffer_load_dwordx4 v[152:155], v225, s[12:15], s86 offen offset:3072 sc1
    s_add_u32 s86, s85, 1
    s_and_b32 s86, s86, 7
    s_lshl_b32 s86, s86, 12
    buffer_load_dwordx4 v[156:159], v225, s[12:15], s86 offen sc1
    buffer_load_dwordx4 v[160:163], v225, s[12:15], s86 offen offset:1024 sc1
    buffer_load_dwordx4 v[164:167], v225, s[12:15], s86 offen offset:2048 sc1
    buffer_load_dwordx4 v[168:171], v225, s[12:15], s86 offen offset:3072 sc1
    s_add_u32 s86, s85, 2
    s_and_b32 s86, s86, 7
    s_lshl_b32 s86, s86, 12
    buffer_load_dwordx4 v[172:175], v225, s[12:15], s86 offen sc1
    buffer_load_dwordx4 v[176:179], v225, s[12:15], s86 offen offset:1024 sc1
    buffer_load_dwordx4 v[180:183], v225, s[12:15], s86 offen offset:2048 sc1
    buffer_load_dwordx4 v[184:187], v225, s[12:15], s86 offen offset:3072 sc1
    s_waitcnt vmcnt(0)
    s_branch L_attn_done
    s_endpgm
L_codeend:
.section .rodata,"a"
.p2align 6
.amdhsa_kernel gated_mix__linear_kernel_hedgehog__mha_block__prompt_kernel
  .amdhsa_next_free_vgpr 256
  .amdhsa_next_free_sgpr 96
  .amdhsa_accum_offset 256
  .amdhsa_group_segment_fixed_size 0
  .amdhsa_kernarg_size 88
  .amdhsa_user_sgpr_count 2
  .amdhsa_user_sgpr_kernarg_segment_ptr 1
  .amdhsa_system_sgpr_workgroup_id_x 1
  .amdhsa_float_denorm_mode_32 3
.end_amdhsa_kernel
```
